```python
import torch

def _softmax(x, axis=-1):
    return torch.softmax(x, dim=axis)
def _gelu(x):
    return torch.nn.functional.gelu(x, approximate="tanh")
def _silu(x):
    return torch.nn.functional.silu(x)
def _sigmoid(x):
    return torch.sigmoid(x)
def _layernorm(x, axis=-1, eps=1e-5):
    m = x.mean(dim=axis, keepdim=True)
    v = x.var(dim=axis, keepdim=True, unbiased=False)
    return (x - m) / torch.sqrt(v + eps)
def _scatter_add(tgt, idx, src, axis=0):
    return tgt.clone().index_add_(axis, idx, src)
def _segment_sum(src, seg, n):
    out = torch.zeros((n,) + src.shape[1:], dtype=src.dtype)
    return out.index_add_(0, seg, src)
def _pad(x, pw):
    flat = tuple(v for pair in reversed(pw) for v in pair)
    return torch.nn.functional.pad(x, flat)

kernel_name = 'gated_mix__ssm_conv_s4d__mixer_token_mlp__prompt'

def setup_inputs():

    _w = (lambda a: (lambda t: t.to(torch.bfloat16) if t.is_floating_point() else t)(torch.as_tensor(a)))
    def _A_setup():
        Bsz, L, D, N = 1, 2048, 640, 128
        return {
            "u": _w((lambda *s: torch.randn(*s, dtype=torch.bfloat16) * 0.05)(Bsz, L, D)),
            "log_A_real": _w((lambda *s: torch.randn(*s, dtype=torch.bfloat16) * 3.2)(D, N) * 0.5),
            "A_imag": _w((lambda *s: torch.randn(*s, dtype=torch.bfloat16) * 0.05)(D, N) * 3.14),
            "C_real": _w((lambda *s: torch.randn(*s, dtype=torch.bfloat16) * 0.1)(D, N) / N ** 0.5),
            "C_imag": _w((lambda *s: torch.randn(*s, dtype=torch.bfloat16) * 0.1)(D, N) / N ** 0.5),
            "log_dt": _w((lambda *s: torch.randn(*s, dtype=torch.bfloat16) * 0.05)(D) * 0.5 - 4.0),
            "D_skip": _w((lambda *s: torch.randn(*s, dtype=torch.bfloat16) * 0.05)(D)),
        }
    _A_in = _A_setup()

    def _B_setup():
        B, S, D, F = 1, 2048, 640, 1728
        return {
            "x": _w((lambda *s: torch.randn(*s, dtype=torch.bfloat16) * 0.05)(B, S, D)),
            "w1": _w((lambda *s: torch.randn(*s, dtype=torch.bfloat16) * 0.2)(S, F) * (S ** -0.5)),
            "b1": _w((lambda *s: torch.randn(*s, dtype=torch.bfloat16) * 3.2)(F) * 0.02),
            "w2": _w((lambda *s: torch.randn(*s, dtype=torch.bfloat16) * 0.05)(F, S) * (F ** -0.5)),
            "b2": _w((lambda *s: torch.randn(*s, dtype=torch.bfloat16) * 0.1)(S) * 0.02),
        }
    _B_in = _B_setup()

    return {
        "A_u": _A_in["u"],
        "A_log_A_real": _A_in["log_A_real"],
        "A_A_imag": _A_in["A_imag"],
        "A_C_real": _A_in["C_real"],
        "A_C_imag": _A_in["C_imag"],
        "A_log_dt": _A_in["log_dt"],
        "A_D_skip": _A_in["D_skip"],
        "B_x": _B_in["x"],
        "B_w1": _B_in["w1"],
        "B_b1": _B_in["b1"],
        "B_w2": _B_in["w2"],
        "B_b2": _B_in["b2"],
        "gate_w": _w((lambda *s: torch.randn(*s, dtype=torch.bfloat16) * 0.05)(640) * 16.0),
    }

def reference(A_u, A_log_A_real, A_A_imag, A_C_real, A_C_imag, A_log_dt, A_D_skip, B_x, B_w1, B_b1, B_w2, B_b2, gate_w):
    def _A_ref(u, log_A_real, A_imag, C_real, C_imag, log_dt, D_skip):
        L = u.shape[1]
        dt = torch.exp(log_dt)
        A = -torch.exp(log_A_real) + 1j * A_imag
        C = (C_real + 1j * C_imag) * dt[:, None]
        pos = (lambda x, dt: x.to(dt))(torch.arange(L), log_dt.dtype)
        P = torch.exp((A * dt[:, None])[:, :, None] * pos[None, None, :])
        K = 2.0 * torch.einsum("dn,dnl->dl", C, P).real
        L2 = 2 * L
        u_t = (lambda x, *d: x.permute(*d))(u, 0, 2, 1)
        Kf = (lambda x, *a, **k: torch.fft.rfft(x.float(), *a, **k))(K, L2)
        Uf = (lambda x, *a, **k: torch.fft.rfft(x.float(), *a, **k))(u_t, L2)
        y = (lambda x, *a, **k: torch.fft.irfft(x, *a, **k).to(torch.bfloat16))(Uf * Kf[None, :, :], L2)[:, :, :L]
        y = (lambda x, *d: x.permute(*d))(y, 0, 2, 1)
        return y + u * D_skip[None, None, :]

    def _B_ref(x, w1, b1, w2, b2):
        B, S, D = x.shape
        h = _layernorm(x, axis=-1)
        u = torch.einsum("bsd,sf->bdf", h, w1) + b1
        u = _gelu(u)
        y = torch.einsum("bdf,fs->bds", u, w2) + b2
        return (lambda x, *d: x.permute(*d))(y, 0, 2, 1)

    x = A_u
    g = _sigmoid((x * gate_w).sum(-1, keepdims=True))
    a = _A_ref(x, A_log_A_real, A_A_imag, A_C_real, A_C_imag, A_log_dt, A_D_skip)
    b = _B_ref(x, B_w1, B_b1, B_w2, B_b2)
    return g * a + (1 - g) * b
```

```asm
; @launch grid=(256,1,1) block=(512,1,1) lds=163840
.amdgcn_target "amdgcn-amd-amdhsa--gfx950"
.text
.globl gated_mix__ssm_conv_s4d__mixer_token_mlp__prompt_kernel
.p2align 8
.type gated_mix__ssm_conv_s4d__mixer_token_mlp__prompt_kernel,@function
gated_mix__ssm_conv_s4d__mixer_token_mlp__prompt_kernel:
s_cmp_ge_u32 s2, 256
s_cbranch_scc1 L_end
s_load_dwordx16 s[36:51], s[0:1], 0
s_load_dwordx16 s[52:67], s[0:1], 64
s_getpc_b64 s[68:69]
L_pc:
v_sub_u32 v22, 511, v0
v_lshlrev_b32 v22, 7, v22
v_min_u32 v22, L_codeend-L_pc-4, v22
global_load_dword v231, v22, s[68:69]
v_lshrrev_b32 v1, 6, v0
v_and_b32 v2, 63, v0
v_mov_b32 v230, 162176
v_mov_b32 v4, 0
v_mov_b32 v5, 0
v_readfirstlane_b32 s3, v1
ds_write_b64 v230, v[4:5] offset:0
ds_write_b64 v230, v[4:5] offset:8
ds_write_b64 v230, v[4:5] offset:16
ds_write_b64 v230, v[4:5] offset:24
ds_write_b64 v230, v[4:5] offset:32
ds_write_b64 v230, v[4:5] offset:40
ds_write_b64 v230, v[4:5] offset:48
ds_write_b64 v230, v[4:5] offset:56
s_and_b32 s8, s2, 7
s_lshr_b32 s9, s2, 3
s_mov_b32 s5, 0
s_and_b32 s10, s9, 7
s_cmp_lt_u32 s8, 3
s_cselect_b32 s83, 32, 24
s_mul_i32 s11, s8, 3
s_min_u32 s68, s8, 3
s_add_u32 s11, s11, s68
s_lshr_b32 s68, s9, 3
s_add_u32 s11, s11, s68
s_cmp_lt_u32 s9, s83
s_cselect_b32 s4, 0, 1
s_cmp_eq_u32 s3, 7
s_cbranch_scc1 L_hwave
s_cmp_eq_u32 s3, 6
s_cbranch_scc1 L_lwave
s_cmp_ge_u32 s3, 4
s_cbranch_scc1 L_cwave
s_setprio 1
s_lshl_b32 s7, s3, 15
s_lshl_b32 s84, s8, 5
s_add_u32 s84, s84, s9
s_lshl_b32 s85, s84, 3
s_lshl_b32 s68, s3, 1
s_add_u32 s85, s85, s68
s_mul_i32 s68, s85, 1280
v_lshlrev_b32 v14, 4, v2
v_lshlrev_b32 v15, 2, v2
v_add_u32 v15, 1024, v15
s_waitcnt lgkmcnt(0)
s_mov_b32 s28, s36
s_and_b32 s29, s37, 0xffff
s_mov_b32 s30, 2621440
s_mov_b32 s31, 0x20000
buffer_load_dwordx4 v[4:7], v14, s[28:31], s68 offen
buffer_load_dword v12, v15, s[28:31], s68 offen
buffer_load_dwordx4 v[8:11], v14, s[28:31], s68 offen offset:1280
buffer_load_dword v13, v15, s[28:31], s68 offen offset:1280
global_load_dwordx4 v[16:19], v14, s[60:61]
global_load_dword v20, v15, s[60:61]
s_add_u32 s24, s66, 12582912
s_addc_u32 s25, s67, 0
s_and_b32 s25, s25, 0xffff
s_mov_b32 s26, 262144
s_mov_b32 s27, 0x20000
v_mov_b32 v21, 0
buffer_load_dword v21, v21, s[24:27], 0 offen sc1
s_cmp_eq_u32 s4, 0
s_cbranch_scc1 L_nopar
s_lshl_b32 s68, s8, 3
s_add_u32 s68, s68, s9
s_sub_u32 s69, 3, s3
s_mul_i32 s69, s69, 40
s_add_u32 s68, s68, s69
s_add_u32 s68, s68, 464
s_min_u32 s68, s68, 639
s_lshl_b32 s68, s68, 8
v_lshl_add_u32 v3, v2, 2, s68
global_load_dword v232, v3, s[38:39]
global_load_dword v233, v3, s[40:41]
global_load_dword v234, v3, s[42:43]
global_load_dword v235, v3, s[44:45]
L_nopar:
s_barrier
s_mov_b32 s12, s52
s_and_b32 s13, s53, 0xffff
s_mov_b32 s14, 7077888
s_mov_b32 s15, 0x20000
v_lshrrev_b32 v204, 3, v2
v_mul_u32_u24 v196, 3456, v204
v_and_b32 v205, 7, v2
v_and_b32 v204, 2, v204
v_xor_b32 v205, v205, v204
v_lshl_add_u32 v196, v205, 4, v196
v_xor_b32 v197, 64, v196
s_add_u32 s74, s3, 16
s_mul_i32 s74, s74, 110592
s_lshl_b32 s81, s11, 7
s_add_u32 s74, s74, s81
s_mov_b32 s75, 442368
s_mov_b32 s76, 7077888
s_mov_b32 s77, 27648
s_mov_b32 s78, s7
s_waitcnt vmcnt(0)
v_lshlrev_b32 v24, 16, v4
v_and_b32 v25, 0xffff0000, v4
v_lshlrev_b32 v26, 16, v5
v_and_b32 v27, 0xffff0000, v5
v_lshlrev_b32 v28, 16, v6
v_and_b32 v29, 0xffff0000, v6
v_lshlrev_b32 v30, 16, v7
v_and_b32 v31, 0xffff0000, v7
v_lshlrev_b32 v32, 16, v12
v_and_b32 v33, 0xffff0000, v12
v_lshlrev_b32 v34, 16, v8
v_and_b32 v35, 0xffff0000, v8
v_lshlrev_b32 v36, 16, v9
v_and_b32 v37, 0xffff0000, v9
v_lshlrev_b32 v38, 16, v10
v_and_b32 v39, 0xffff0000, v10
v_lshlrev_b32 v40, 16, v11
v_and_b32 v41, 0xffff0000, v11
v_lshlrev_b32 v42, 16, v13
v_and_b32 v43, 0xffff0000, v13
v_lshlrev_b32 v44, 16, v16
v_and_b32 v45, 0xffff0000, v16
v_lshlrev_b32 v46, 16, v17
v_and_b32 v47, 0xffff0000, v17
v_lshlrev_b32 v48, 16, v18
v_and_b32 v49, 0xffff0000, v18
v_lshlrev_b32 v50, 16, v19
v_and_b32 v51, 0xffff0000, v19
v_lshlrev_b32 v52, 16, v20
v_and_b32 v53, 0xffff0000, v20
v_readfirstlane_b32 s6, v21
v_readlane_b32 s68, v24, 0
v_readlane_b32 s70, v34, 0
s_add_u32 s6, s6, 0x9e3779b9
s_mov_b32 s69, s68
s_mov_b32 s71, s70
s_mul_i32 s72, s3, 2688
s_add_u32 s72, s72, 131072
v_add_u32 v22, s72, v14
v_add_u32 v23, s72, v15
v_pk_add_f32 v[54:55], v[24:25], s[68:69] neg_lo:[0,1] neg_hi:[0,1]
v_pk_add_f32 v[56:57], v[26:27], s[68:69] neg_lo:[0,1] neg_hi:[0,1]
v_pk_add_f32 v[58:59], v[28:29], s[68:69] neg_lo:[0,1] neg_hi:[0,1]
v_pk_add_f32 v[60:61], v[30:31], s[68:69] neg_lo:[0,1] neg_hi:[0,1]
v_pk_add_f32 v[62:63], v[32:33], s[68:69] neg_lo:[0,1] neg_hi:[0,1]
v_pk_mul_f32 v[64:65], v[24:25], v[44:45]
v_pk_mul_f32 v[66:67], v[26:27], v[46:47]
v_pk_mul_f32 v[68:69], v[28:29], v[48:49]
v_pk_mul_f32 v[70:71], v[30:31], v[50:51]
v_pk_mul_f32 v[72:73], v[32:33], v[52:53]
v_pk_add_f32 v[74:75], v[34:35], s[70:71] neg_lo:[0,1] neg_hi:[0,1]
v_pk_add_f32 v[76:77], v[36:37], s[70:71] neg_lo:[0,1] neg_hi:[0,1]
v_pk_add_f32 v[78:79], v[38:39], s[70:71] neg_lo:[0,1] neg_hi:[0,1]
v_pk_add_f32 v[80:81], v[40:41], s[70:71] neg_lo:[0,1] neg_hi:[0,1]
v_pk_add_f32 v[82:83], v[42:43], s[70:71] neg_lo:[0,1] neg_hi:[0,1]
v_pk_mul_f32 v[84:85], v[34:35], v[44:45]
v_pk_mul_f32 v[86:87], v[36:37], v[46:47]
v_pk_mul_f32 v[88:89], v[38:39], v[48:49]
v_pk_mul_f32 v[90:91], v[40:41], v[50:51]
v_pk_mul_f32 v[92:93], v[42:43], v[52:53]
v_pk_mul_f32 v[96:97], v[54:55], v[54:55]
v_pk_add_f32 v[94:95], v[54:55], v[56:57]
v_cvt_pk_bf16_f32 v64, v64, v65
v_cvt_pk_bf16_f32 v66, v66, v67
v_cvt_pk_bf16_f32 v68, v68, v69
v_cvt_pk_bf16_f32 v70, v70, v71
v_cvt_pk_bf16_f32 v72, v72, v73
v_pk_fma_f32 v[96:97], v[56:57], v[56:57], v[96:97]
v_pk_fma_f32 v[96:97], v[58:59], v[58:59], v[96:97]
v_pk_add_f32 v[94:95], v[94:95], v[58:59]
v_pk_fma_f32 v[96:97], v[60:61], v[60:61], v[96:97]
v_pk_add_f32 v[94:95], v[94:95], v[60:61]
v_pk_fma_f32 v[96:97], v[62:63], v[62:63], v[96:97]
v_pk_add_f32 v[94:95], v[94:95], v[62:63]
v_and_b32 v65, 0xffff0000, v64
v_lshlrev_b32 v64, 16, v64
v_and_b32 v67, 0xffff0000, v66
v_lshlrev_b32 v66, 16, v66
v_and_b32 v69, 0xffff0000, v68
v_lshlrev_b32 v68, 16, v68
v_and_b32 v71, 0xffff0000, v70
v_lshlrev_b32 v70, 16, v70
v_and_b32 v73, 0xffff0000, v72
v_lshlrev_b32 v72, 16, v72
v_pk_add_f32 v[98:99], v[64:65], v[66:67]
v_pk_add_f32 v[68:69], v[68:69], v[70:71]
v_pk_add_f32 v[98:99], v[98:99], v[72:73]
v_pk_add_f32 v[98:99], v[98:99], v[68:69]
v_pk_mul_f32 v[102:103], v[74:75], v[74:75]
v_pk_add_f32 v[100:101], v[74:75], v[76:77]
v_cvt_pk_bf16_f32 v84, v84, v85
v_cvt_pk_bf16_f32 v86, v86, v87
v_cvt_pk_bf16_f32 v88, v88, v89
v_cvt_pk_bf16_f32 v90, v90, v91
v_cvt_pk_bf16_f32 v92, v92, v93
v_pk_fma_f32 v[102:103], v[76:77], v[76:77], v[102:103]
v_pk_fma_f32 v[102:103], v[78:79], v[78:79], v[102:103]
v_pk_add_f32 v[100:101], v[100:101], v[78:79]
v_pk_fma_f32 v[102:103], v[80:81], v[80:81], v[102:103]
v_pk_add_f32 v[100:101], v[100:101], v[80:81]
v_pk_fma_f32 v[102:103], v[82:83], v[82:83], v[102:103]
v_pk_add_f32 v[100:101], v[100:101], v[82:83]
v_and_b32 v85, 0xffff0000, v84
v_lshlrev_b32 v84, 16, v84
v_and_b32 v87, 0xffff0000, v86
v_lshlrev_b32 v86, 16, v86
v_and_b32 v89, 0xffff0000, v88
v_lshlrev_b32 v88, 16, v88
v_and_b32 v91, 0xffff0000, v90
v_lshlrev_b32 v90, 16, v90
v_and_b32 v93, 0xffff0000, v92
v_lshlrev_b32 v92, 16, v92
v_pk_add_f32 v[104:105], v[84:85], v[86:87]
v_pk_add_f32 v[88:89], v[88:89], v[90:91]
v_pk_add_f32 v[104:105], v[104:105], v[92:93]
v_pk_add_f32 v[104:105], v[104:105], v[88:89]
v_add_f32 v106, v94, v95
v_add_f32 v108, v96, v97
v_add_f32 v110, v98, v99
v_add_f32 v107, v100, v101
v_add_f32 v109, v102, v103
v_add_f32 v111, v104, v105
v_permlane32_swap_b32 v106, v107
v_permlane32_swap_b32 v108, v109
v_permlane32_swap_b32 v110, v111
v_add_f32 v106, v106, v107
v_add_f32 v108, v108, v109
v_add_f32 v110, v110, v111
v_add_f32_dpp v106, v106, v106 quad_perm:[1,0,3,2] row_mask:0xf bank_mask:0xf
v_add_f32_dpp v108, v108, v108 quad_perm:[1,0,3,2] row_mask:0xf bank_mask:0xf
v_add_f32_dpp v110, v110, v110 quad_perm:[1,0,3,2] row_mask:0xf bank_mask:0xf
v_add_f32_dpp v106, v106, v106 quad_perm:[2,3,0,1] row_mask:0xf bank_mask:0xf
v_add_f32_dpp v108, v108, v108 quad_perm:[2,3,0,1] row_mask:0xf bank_mask:0xf
v_add_f32_dpp v110, v110, v110 quad_perm:[2,3,0,1] row_mask:0xf bank_mask:0xf
v_add_f32_dpp v106, v106, v106 row_half_mirror row_mask:0xf bank_mask:0xf
v_add_f32_dpp v108, v108, v108 row_half_mirror row_mask:0xf bank_mask:0xf
v_add_f32_dpp v110, v110, v110 row_half_mirror row_mask:0xf bank_mask:0xf
v_add_f32_dpp v106, v106, v106 row_mirror row_mask:0xf bank_mask:0xf
v_add_f32_dpp v108, v108, v108 row_mirror row_mask:0xf bank_mask:0xf
v_add_f32_dpp v110, v110, v110 row_mirror row_mask:0xf bank_mask:0xf
v_mov_b32 v107, v106
v_mov_b32 v109, v108
v_mov_b32 v111, v110
v_mov_b32 v112, s68
s_mov_b32 exec_lo, 0
v_mov_b32 v112, s70
s_mov_b32 exec_lo, -1
v_permlane16_swap_b32 v106, v107
v_permlane16_swap_b32 v108, v109
v_permlane16_swap_b32 v110, v111
v_add_f32 v106, v106, v107
v_add_f32 v108, v108, v109
v_add_f32 v110, v110, v111
v_mul_f32 v106, 0x3acccccd, v106
v_mul_f32 v108, 0x3acccccd, v108
v_fma_f32 v108, -v106, v106, v108
v_add_f32 v106, v106, v112
v_max_f32 v108, 0, v108
v_cvt_pk_bf16_f32 v110, v110, v110
v_and_b32 v110, 0xffff0000, v110
v_cvt_pk_bf16_f32 v108, v108, v108
v_and_b32 v108, 0xffff0000, v108
v_cvt_pk_bf16_f32 v106, v106, v106
v_and_b32 v106, 0xffff0000, v106
v_add_f32 v108, 0x3727c5ac, v108
v_mul_f32 v110, 0xbfb8aa3b, v110
v_cvt_pk_bf16_f32 v108, v108, v108
v_and_b32 v108, 0xffff0000, v108
v_exp_f32 v110, v110
v_sqrt_f32 v108, v108
v_readlane_b32 s68, v106, 0
v_readlane_b32 s70, v106, 32
v_add_f32 v110, 1.0, v110
v_cvt_pk_bf16_f32 v108, v108, v108
v_and_b32 v108, 0xffff0000, v108
v_rcp_f32 v110, v110
v_rcp_f32 v108, v108
s_mov_b32 s69, s68
s_mov_b32 s71, s70
v_pk_add_f32 v[54:55], v[24:25], s[68:69] neg_lo:[0,1] neg_hi:[0,1]
v_pk_add_f32 v[56:57], v[26:27], s[68:69] neg_lo:[0,1] neg_hi:[0,1]
v_pk_add_f32 v[58:59], v[28:29], s[68:69] neg_lo:[0,1] neg_hi:[0,1]
v_pk_add_f32 v[60:61], v[30:31], s[68:69] neg_lo:[0,1] neg_hi:[0,1]
v_pk_add_f32 v[62:63], v[32:33], s[68:69] neg_lo:[0,1] neg_hi:[0,1]
v_pk_add_f32 v[74:75], v[34:35], s[70:71] neg_lo:[0,1] neg_hi:[0,1]
v_pk_add_f32 v[76:77], v[36:37], s[70:71] neg_lo:[0,1] neg_hi:[0,1]
v_pk_add_f32 v[78:79], v[38:39], s[70:71] neg_lo:[0,1] neg_hi:[0,1]
v_pk_add_f32 v[80:81], v[40:41], s[70:71] neg_lo:[0,1] neg_hi:[0,1]
v_pk_add_f32 v[82:83], v[42:43], s[70:71] neg_lo:[0,1] neg_hi:[0,1]
v_readlane_b32 s68, v108, 0
v_readlane_b32 s70, v108, 32
v_cvt_pk_bf16_f32 v112, v110, v110
v_and_b32 v112, 0xffff0000, v112
v_cvt_pk_bf16_f32 v54, v54, v55
v_cvt_pk_bf16_f32 v56, v56, v57
v_cvt_pk_bf16_f32 v58, v58, v59
v_cvt_pk_bf16_f32 v60, v60, v61
v_cvt_pk_bf16_f32 v62, v62, v63
v_cvt_pk_bf16_f32 v74, v74, v75
v_cvt_pk_bf16_f32 v76, v76, v77
v_cvt_pk_bf16_f32 v78, v78, v79
v_cvt_pk_bf16_f32 v80, v80, v81
v_cvt_pk_bf16_f32 v82, v82, v83
s_mov_b32 s69, s68
s_mov_b32 s71, s70
v_sub_f32 v113, 1.0, v112
v_and_b32 v55, 0xffff0000, v54
v_lshlrev_b32 v54, 16, v54
v_and_b32 v57, 0xffff0000, v56
v_lshlrev_b32 v56, 16, v56
v_and_b32 v59, 0xffff0000, v58
v_lshlrev_b32 v58, 16, v58
v_and_b32 v61, 0xffff0000, v60
v_lshlrev_b32 v60, 16, v60
v_and_b32 v63, 0xffff0000, v62
v_lshlrev_b32 v62, 16, v62
v_and_b32 v75, 0xffff0000, v74
v_lshlrev_b32 v74, 16, v74
v_and_b32 v77, 0xffff0000, v76
v_lshlrev_b32 v76, 16, v76
v_and_b32 v79, 0xffff0000, v78
v_lshlrev_b32 v78, 16, v78
v_and_b32 v81, 0xffff0000, v80
v_lshlrev_b32 v80, 16, v80
v_and_b32 v83, 0xffff0000, v82
v_lshlrev_b32 v82, 16, v82
v_cvt_pk_bf16_f32 v113, v113, v113
v_and_b32 v113, 0xffff0000, v113
v_pk_mul_f32 v[54:55], v[54:55], s[68:69]
v_pk_mul_f32 v[56:57], v[56:57], s[68:69]
v_pk_mul_f32 v[58:59], v[58:59], s[68:69]
v_pk_mul_f32 v[60:61], v[60:61], s[68:69]
v_pk_mul_f32 v[62:63], v[62:63], s[68:69]
v_pk_mul_f32 v[74:75], v[74:75], s[70:71]
v_pk_mul_f32 v[76:77], v[76:77], s[70:71]
v_pk_mul_f32 v[78:79], v[78:79], s[70:71]
v_pk_mul_f32 v[80:81], v[80:81], s[70:71]
v_pk_mul_f32 v[82:83], v[82:83], s[70:71]
v_cvt_pk_bf16_f32 v24, v54, v55
v_cvt_pk_bf16_f32 v25, v56, v57
v_cvt_pk_bf16_f32 v26, v58, v59
v_cvt_pk_bf16_f32 v27, v60, v61
v_cvt_pk_bf16_f32 v28, v62, v63
ds_write_b128 v22, v[24:27] offset:0
ds_write_b32 v23, v28 offset:0
v_cvt_pk_bf16_f32 v30, v74, v75
v_cvt_pk_bf16_f32 v31, v76, v77
v_cvt_pk_bf16_f32 v32, v78, v79
v_cvt_pk_bf16_f32 v33, v80, v81
v_cvt_pk_bf16_f32 v34, v82, v83
ds_write_b128 v22, v[30:33] offset:1344
ds_write_b32 v23, v34 offset:1344
s_mov_b64 exec, 1
v_mov_b32 v36, 1
ds_add_u32 v230, v36 offset:0
s_mov_b64 exec, -1
v_lshrrev_b32 v37, 4, v2
v_bfe_u32 v38, v2, 2, 2
v_and_b32 v39, 3, v2
v_and_b32 v40, 15, v2
v_lshrrev_b32 v41, 1, v38
v_mul_u32_u24 v41, 2688, v41
v_and_b32 v42, 1, v38
v_mul_u32_u24 v42, 1344, v42
s_lshl_b32 s72, s3, 7
s_add_u32 s72, s72, 131072
v_add3_u32 v41, v41, v42, s72
v_lshl_add_u32 v41, v37, 5, v41
v_lshl_add_u32 v41, v39, 3, v41
v_add_u32 v42, 5376, v41
s_lshl_b32 s72, s3, 12
v_lshlrev_b32 v45, 10, v37
v_lshl_add_u32 v45, v40, 4, v45
v_add_u32 v45, s72, v45
s_lshr_b32 s72, s84, 2
s_mul_i32 s72, s72, 40960
s_and_b32 s73, s84, 3
s_lshl_b32 s73, s73, 8
s_add_u32 s72, s72, s73
s_add_u32 s20, s66, 0
s_addc_u32 s21, s67, 0
s_and_b32 s21, s21, 0xffff
s_mov_b32 s22, 5242880
s_mov_b32 s23, 0x20000
s_add_u32 s32, s66, 10485760
s_addc_u32 s33, s67, 0
s_and_b32 s33, s33, 0xffff
s_mov_b32 s34, 16384
s_mov_b32 s35, 0x20000
v_lshrrev_b32 v46, 5, v2
v_lshlrev_b32 v46, 3, v46
s_lshl_b32 s73, s85, 3
s_mov_b32 exec_lo, 1
s_mov_b32 exec_hi, 1
buffer_store_dwordx2 v[112:113], v46, s[32:35], s73 offen sc1
s_mov_b64 exec, -1
s_add_u32 s5, s5, 4
s_mov_b32 s69, 0
Lw1:
ds_read_b32 v36, v230 offset:0
s_add_u32 s69, s69, 1
s_waitcnt lgkmcnt(0)
v_readfirstlane_b32 s68, v36
s_cmp_ge_u32 s68, s5
s_cbranch_scc1 Le2
s_cmp_lt_u32 s69, 2097152
s_cbranch_scc1 Lw1
Le2:
ds_read_b64_tr_b16 v[48:49], v41 offset:0
ds_read_b64_tr_b16 v[50:51], v42 offset:0
ds_read_b64_tr_b16 v[52:53], v41 offset:512
ds_read_b64_tr_b16 v[54:55], v42 offset:512
ds_read_b64_tr_b16 v[56:57], v41 offset:1024
ds_read_b64_tr_b16 v[58:59], v42 offset:1024
s_waitcnt lgkmcnt(4)
buffer_store_dwordx4 v[48:51], v45, s[20:23], s72 offen sc1
s_add_u32 s72, s72, 16384
s_waitcnt lgkmcnt(2)
buffer_store_dwordx4 v[52:55], v45, s[20:23], s72 offen sc1
s_add_u32 s72, s72, 16384
s_cmp_ge_u32 s3, 2
s_cbranch_scc1 L_no3
s_waitcnt lgkmcnt(0)
buffer_store_dwordx4 v[56:59], v45, s[20:23], s72 offen sc1
L_no3:
s_waitcnt lgkmcnt(0)
s_mov_b64 exec, 1
v_mov_b32 v36, 1
ds_add_u32 v230, v36 offset:16
s_mov_b64 exec, -1
s_waitcnt vmcnt(0)
s_add_u32 s5, s5, 4
s_mov_b64 exec, 1
v_mov_b32 v36, 1
ds_add_u32 v230, v36 offset:0
s_mov_b64 exec, -1
s_mov_b32 s69, 0
Lw3:
ds_read_b32 v36, v230 offset:0
s_add_u32 s69, s69, 1
s_waitcnt lgkmcnt(0)
v_readfirstlane_b32 s68, v36
s_cmp_ge_u32 s68, s5
s_cbranch_scc1 Le4
s_cmp_lt_u32 s69, 2097152
s_cbranch_scc1 Lw3
Le4:
s_cmp_lg_u32 s3, 0
s_cbranch_scc1 L_noflag1
s_mov_b32 s69, 0
Lw5:
ds_read_b32 v36, v230 offset:32
s_add_u32 s69, s69, 1
s_waitcnt lgkmcnt(0)
v_readfirstlane_b32 s68, v36
s_cmp_ge_u32 s68, 1
s_cbranch_scc1 Le6
s_cmp_lt_u32 s69, 2097152
s_cbranch_scc1 Lw5
Le6:
s_lshr_b32 s72, s84, 2
s_lshl_b32 s72, s72, 7
s_and_b32 s73, s84, 3
s_lshl_b32 s73, s73, 2
s_add_u32 s72, s72, s73
s_add_u32 s72, s72, 4096
s_mov_b64 exec, 1
v_mov_b32 v36, s6
v_mov_b32 v37, 0
buffer_store_dword v36, v37, s[24:27], s72 offen sc1
s_mov_b64 exec, -1
s_mov_b64 exec, 1
v_mov_b32 v36, 1
ds_add_u32 v230, v36 offset:40
s_mov_b64 exec, -1
L_noflag1:
s_cmp_lg_u32 s4, 0
s_cbranch_scc1 L_nogd1
s_mov_b32 s69, 0
Lw7:
ds_read_b32 v36, v230 offset:40
s_add_u32 s69, s69, 1
s_waitcnt lgkmcnt(0)
v_readfirstlane_b32 s68, v36
s_cmp_ge_u32 s68, 1
s_cbranch_scc1 Le8
s_cmp_lt_u32 s69, 2097152
s_cbranch_scc1 Lw7
Le8:
s_add_u32 m0, s78, 16384
s_nop 0
buffer_load_dwordx4 v196, s[12:15], s74 offen  lds
s_add_u32 m0, s78, 17408
s_add_u32 s81, s74, s77
buffer_load_dwordx4 v197, s[12:15], s81 offen  lds
s_add_u32 m0, s78, 18432
s_add_u32 s81, s81, s77
buffer_load_dwordx4 v196, s[12:15], s81 offen  lds
s_add_u32 m0, s78, 19456
s_add_u32 s81, s81, s77
buffer_load_dwordx4 v197, s[12:15], s81 offen  lds
s_add_u32 s74, s74, s75
s_add_u32 m0, s78, 20480
s_nop 0
buffer_load_dwordx4 v196, s[12:15], s74 offen  lds
s_add_u32 m0, s78, 21504
s_add_u32 s81, s74, s77
buffer_load_dwordx4 v197, s[12:15], s81 offen  lds
s_add_u32 m0, s78, 22528
s_add_u32 s81, s81, s77
buffer_load_dwordx4 v196, s[12:15], s81 offen  lds
s_add_u32 m0, s78, 23552
s_add_u32 s81, s81, s77
buffer_load_dwordx4 v197, s[12:15], s81 offen  lds
s_add_u32 s74, s74, s75
s_add_u32 m0, s78, 24576
s_nop 0
buffer_load_dwordx4 v196, s[12:15], s74 offen  lds
s_add_u32 m0, s78, 25600
s_add_u32 s81, s74, s77
buffer_load_dwordx4 v197, s[12:15], s81 offen  lds
s_add_u32 m0, s78, 26624
s_add_u32 s81, s81, s77
buffer_load_dwordx4 v196, s[12:15], s81 offen  lds
s_add_u32 m0, s78, 27648
s_add_u32 s81, s81, s77
buffer_load_dwordx4 v197, s[12:15], s81 offen  lds
s_add_u32 s74, s74, s75
s_add_u32 m0, s78, 28672
s_nop 0
buffer_load_dwordx4 v196, s[12:15], s74 offen  lds
s_add_u32 m0, s78, 29696
s_add_u32 s81, s74, s77
buffer_load_dwordx4 v197, s[12:15], s81 offen  lds
s_add_u32 m0, s78, 30720
s_add_u32 s81, s81, s77
buffer_load_dwordx4 v196, s[12:15], s81 offen  lds
s_add_u32 m0, s78, 31744
s_add_u32 s81, s81, s77
buffer_load_dwordx4 v197, s[12:15], s81 offen  lds
s_add_u32 s74, s74, s75
L_nogd1:
v_lshlrev_b32 v198, 4, v2
v_add_u32 v199, 4096, v198
v_mov_b32 v229, 0
v_lshrrev_b32 v204, 4, v2
v_bfe_u32 v205, v2, 2, 2
v_lshlrev_b32 v200, 10, v204
v_lshl_add_u32 v200, v205, 7, v200
v_and_b32 v204, 1, v204
v_lshlrev_b32 v204, 1, v204
v_lshrrev_b32 v205, 1, v205
v_or_b32 v204, v204, v205
v_lshl_add_u32 v200, v204, 5, v200
v_and_b32 v205, 3, v2
v_lshl_add_u32 v200, v205, 3, v200
v_add_u32 v204, s7, v200
s_add_u32 s68, s3, 0
s_and_b32 s68, s68, 3
s_lshl_b32 s68, s68, 5
v_xor_b32 v200, s68, v204
s_add_u32 s68, s3, 1
s_and_b32 s68, s68, 3
s_lshl_b32 s68, s68, 5
v_xor_b32 v201, s68, v204
s_add_u32 s68, s3, 2
s_and_b32 s68, s68, 3
s_lshl_b32 s68, s68, 5
v_xor_b32 v202, s68, v204
s_add_u32 s68, s3, 3
s_and_b32 s68, s68, 3
s_lshl_b32 s68, s68, 5
v_xor_b32 v203, s68, v204
s_mul_i32 s68, s10, 5120
s_add_u32 s16, s66, s68
s_addc_u32 s17, s67, 0
s_and_b32 s17, s17, 0xffff
s_mov_b32 s18, 5242880
s_mov_b32 s19, 0x20000
s_cmp_lg_u32 s4, 0
s_cbranch_scc1 L_freecu
v_lshrrev_b32 v206, 4, v2
v_lshlrev_b32 v206, 3, v206
s_lshl_b32 s68, s3, 5
s_lshl_b32 s69, s11, 7
s_add_u32 s68, s68, s69
v_add_u32 v206, s68, v206
global_load_dwordx2 v[206:207], v206, s[54:55]
s_mul_i32 s70, s3, 40960
s_mov_b32 s71, 163840
s_mov_b32 s72, 2621440
s_mov_b32 s73, 0x500000
s_mov_b32 s80, 1
s_mul_i32 s68, s10, 5120
s_add_u32 s68, s68, 5242880
s_add_u32 s28, s66, s68
s_addc_u32 s29, s67, 0
s_and_b32 s29, s29, 0xffff
s_mov_b32 s30, 2211840
s_mov_b32 s31, 0x20000
s_lshl_b32 s84, s11, 1
s_lshr_b32 s69, s3, 1
s_add_u32 s84, s84, s69
s_mul_i32 s84, s84, 40960
s_and_b32 s69, s3, 1
s_lshl_b32 s69, s69, 9
s_add_u32 s84, s84, s69
s_add_u32 s85, s84, 4096
v_bfe_u32 v208, v2, 4, 1
v_lshlrev_b32 v208, 10, v208
v_lshrrev_b32 v11, 5, v2
v_lshl_add_u32 v208, v11, 8, v208
v_and_b32 v11, 15, v2
v_lshl_add_u32 v208, v11, 4, v208
s_lshl_b32 s50, s10, 5
s_add_u32 s50, s50, s11
s_lshl_b32 s50, s50, 7
s_lshl_b32 s69, s3, 2
s_add_u32 s50, s50, s69
s_add_u32 s50, s50, 65536
L_waitf1:
v_mov_b32 v116, 0
v_mov_b32 v117, 0
v_mov_b32 v118, 0
v_mov_b32 v119, 0
v_mov_b32 v120, 0
v_mov_b32 v121, 0
v_mov_b32 v122, 0
v_mov_b32 v123, 0
v_mov_b32 v124, 0
v_mov_b32 v125, 0
v_mov_b32 v126, 0
v_mov_b32 v127, 0
v_mov_b32 v128, 0
v_mov_b32 v129, 0
v_mov_b32 v130, 0
v_mov_b32 v131, 0
v_mov_b32 v132, 0
v_mov_b32 v133, 0
v_mov_b32 v134, 0
v_mov_b32 v135, 0
v_mov_b32 v136, 0
v_mov_b32 v137, 0
v_mov_b32 v138, 0
v_mov_b32 v139, 0
v_mov_b32 v140, 0
v_mov_b32 v141, 0
v_mov_b32 v142, 0
v_mov_b32 v143, 0
v_mov_b32 v144, 0
v_mov_b32 v145, 0
v_mov_b32 v146, 0
v_mov_b32 v147, 0
v_mov_b32 v148, 0
v_mov_b32 v149, 0
v_mov_b32 v150, 0
v_mov_b32 v151, 0
v_mov_b32 v152, 0
v_mov_b32 v153, 0
v_mov_b32 v154, 0
v_mov_b32 v155, 0
v_mov_b32 v156, 0
v_mov_b32 v157, 0
v_mov_b32 v158, 0
v_mov_b32 v159, 0
v_mov_b32 v160, 0
v_mov_b32 v161, 0
v_mov_b32 v162, 0
v_mov_b32 v163, 0
v_mov_b32 v164, 0
v_mov_b32 v165, 0
v_mov_b32 v166, 0
v_mov_b32 v167, 0
v_mov_b32 v168, 0
v_mov_b32 v169, 0
v_mov_b32 v170, 0
v_mov_b32 v171, 0
v_mov_b32 v172, 0
v_mov_b32 v173, 0
v_mov_b32 v174, 0
v_mov_b32 v175, 0
v_mov_b32 v176, 0
v_mov_b32 v177, 0
v_mov_b32 v178, 0
v_mov_b32 v179, 0
v_mov_b32 v180, 0
v_mov_b32 v181, 0
v_mov_b32 v182, 0
v_mov_b32 v183, 0
v_mov_b32 v184, 0
v_mov_b32 v185, 0
v_mov_b32 v186, 0
v_mov_b32 v187, 0
v_mov_b32 v188, 0
v_mov_b32 v189, 0
v_mov_b32 v190, 0
v_mov_b32 v191, 0
v_mov_b32 v192, 0
v_mov_b32 v193, 0
v_mov_b32 v194, 0
v_mov_b32 v195, 0
s_cmp_lg_u32 s3, 0
s_cbranch_scc1 Lf9
v_lshlrev_b32 v36, 7, v2
s_mov_b32 s51, 4096
s_mov_b32 s69, 0
Lw11:
ds_read_b32 v40, v230 offset:24
s_add_u32 s69, s69, 1
s_waitcnt lgkmcnt(0)
v_readfirstlane_b32 s68, v40
s_cmp_ge_u32 s68, 1
s_cbranch_scc1 Le12
s_sleep 1
s_cmp_lt_u32 s69, 2097152
s_cbranch_scc1 Lw11
Le12:
s_mov_b32 s69, 0
Lp13:
buffer_load_dwordx4 v[40:43], v36, s[24:27], s51 offen sc1
s_add_u32 s69, s69, 1
s_waitcnt vmcnt(0)
v_xor_b32 v40, s6, v40
v_xor_b32 v41, s6, v41
v_xor_b32 v42, s6, v42
v_xor_b32 v43, s6, v43
v_or3_b32 v40, v40, v41, v42
v_or_b32 v40, v40, v43
v_cmp_ne_u32 vcc, 0, v40
s_and_b64 exec, exec, vcc
s_cbranch_execz Lq14
s_sleep 1
s_cmp_lt_u32 s69, 131072
s_cbranch_scc1 Lp13
Lq14:
s_mov_b64 exec, -1
v_mov_b32 v36, s6
ds_write_b32 v230, v36 offset:12
s_mov_b64 exec, 1
v_mov_b32 v36, 1
ds_add_u32 v230, v36 offset:4
s_mov_b64 exec, -1
s_cmp_lg_u32 s2, 0
s_cbranch_scc1 Lf10
s_mov_b64 exec, 1
v_mov_b32 v36, s6
v_mov_b32 v37, 0
buffer_store_dword v36, v37, s[24:27], 0 offen sc1
s_mov_b64 exec, -1
s_branch Lf10
Lf9:
s_mov_b32 s69, 0
Lw15:
ds_read_b32 v36, v230 offset:4
s_add_u32 s69, s69, 1
s_waitcnt lgkmcnt(0)
v_readfirstlane_b32 s68, v36
s_cmp_ge_u32 s68, 1
s_cbranch_scc1 Le16
s_sleep 1
s_cmp_lt_u32 s69, 2097152
s_cbranch_scc1 Lw15
Le16:
ds_read_b32 v36, v230 offset:12
s_waitcnt lgkmcnt(0)
v_readfirstlane_b32 s6, v36
Lf10:
s_mov_b32 s69, 0
Lw17:
ds_read_b32 v36, v230 offset:36
s_add_u32 s69, s69, 1
s_waitcnt lgkmcnt(0)
v_readfirstlane_b32 s68, v36
s_cmp_ge_u32 s68, 1
s_cbranch_scc1 Le18
s_cmp_lt_u32 s69, 2097152
s_cbranch_scc1 Lw17
Le18:
s_cmp_lg_u32 s4, 0
s_cbranch_scc1 L_chan_ret
L_gemm:
s_mov_b32 s87, 0
s_lshl_b32 s88, s77, 1
s_sub_u32 s89, s75, s88
s_xor_b32 s89, s89, s88
s_cmp_lt_u32 s70, s72
s_cselect_b32 s18, s73, 0
buffer_load_dwordx4 v[36:39], v198, s[16:19], s70 offen offset:0 sc1
buffer_load_dwordx4 v[40:43], v198, s[16:19], s70 offen offset:1024 sc1
buffer_load_dwordx4 v[44:47], v198, s[16:19], s70 offen offset:2048 sc1
buffer_load_dwordx4 v[48:51], v198, s[16:19], s70 offen offset:3072 sc1
buffer_load_dwordx4 v[52:55], v199, s[16:19], s70 offen sc1
s_add_u32 s70, s70, s71
s_cmp_lt_u32 s70, s72
s_cselect_b32 s18, s73, 0
buffer_load_dwordx4 v[56:59], v198, s[16:19], s70 offen offset:0 sc1
buffer_load_dwordx4 v[60:63], v198, s[16:19], s70 offen offset:1024 sc1
buffer_load_dwordx4 v[64:67], v198, s[16:19], s70 offen offset:2048 sc1
buffer_load_dwordx4 v[68:71], v198, s[16:19], s70 offen offset:3072 sc1
buffer_load_dwordx4 v[72:75], v199, s[16:19], s70 offen sc1
s_add_u32 s70, s70, s71
s_cmp_lt_u32 s70, s72
s_cselect_b32 s18, s73, 0
buffer_load_dwordx4 v[76:79], v198, s[16:19], s70 offen offset:0 sc1
buffer_load_dwordx4 v[80:83], v198, s[16:19], s70 offen offset:1024 sc1
buffer_load_dwordx4 v[84:87], v198, s[16:19], s70 offen offset:2048 sc1
buffer_load_dwordx4 v[88:91], v198, s[16:19], s70 offen offset:3072 sc1
buffer_load_dwordx4 v[92:95], v199, s[16:19], s70 offen sc1
s_add_u32 s70, s70, s71
s_mov_b32 s79, s4
ds_read_b64_tr_b16 v[4:5], v200 offset:0
ds_read_b64_tr_b16 v[6:7], v200 offset:512
ds_read_b64_tr_b16 v[8:9], v201 offset:0
ds_read_b64_tr_b16 v[10:11], v201 offset:512
ds_read_b64_tr_b16 v[12:13], v202 offset:0
ds_read_b64_tr_b16 v[14:15], v202 offset:512
ds_read_b64_tr_b16 v[16:17], v203 offset:0
ds_read_b64_tr_b16 v[18:19], v203 offset:512
.p2align 3
L_loop:
s_waitcnt vmcnt(10)
ds_read_b64_tr_b16 v[20:21], v200 offset:4096
ds_read_b64_tr_b16 v[22:23], v200 offset:4608
ds_read_b64_tr_b16 v[24:25], v201 offset:4096
ds_read_b64_tr_b16 v[26:27], v201 offset:4608
ds_read_b64_tr_b16 v[28:29], v202 offset:4096
ds_read_b64_tr_b16 v[30:31], v202 offset:4608
ds_read_b64_tr_b16 v[32:33], v203 offset:4096
ds_read_b64_tr_b16 v[34:35], v203 offset:4608
s_waitcnt lgkmcnt(8)
s_cmp_lt_u32 s74, s76
s_cbranch_scc0 Ls19
s_add_u32 m0, s7, s87
s_add_u32 s81, s74, s77
buffer_load_dwordx4 v196, s[12:15], s74 offen  lds
s_add_u32 m0, m0, 1024
s_add_u32 s74, s74, s88
buffer_load_dwordx4 v197, s[12:15], s81 offen  lds
s_xor_b32 s88, s88, s89
s_add_u32 s87, s87, 2048
Ls19:
s_cmp_lt_u32 s74, s76
s_cbranch_scc0 Ls20
s_add_u32 m0, s7, s87
s_add_u32 s81, s74, s77
buffer_load_dwordx4 v196, s[12:15], s74 offen  lds
s_add_u32 m0, m0, 1024
s_add_u32 s74, s74, s88
buffer_load_dwordx4 v197, s[12:15], s81 offen  lds
s_xor_b32 s88, s88, s89
s_add_u32 s87, s87, 2048
Ls20:
s_cmp_lt_u32 s70, s72
s_cselect_b32 s18, s73, 0
v_mfma_f32_16x16x32_bf16 v[116:119], v[4:7], v[36:39], v[116:119]
v_mfma_f32_16x16x32_bf16 v[136:139], v[8:11], v[36:39], v[136:139]
v_mfma_f32_16x16x32_bf16 v[156:159], v[12:15], v[36:39], v[156:159]
v_mfma_f32_16x16x32_bf16 v[176:179], v[16:19], v[36:39], v[176:179]
buffer_load_dwordx4 v[96:99], v198, s[16:19], s70 offen offset:0 sc1
v_mfma_f32_16x16x32_bf16 v[120:123], v[4:7], v[40:43], v[120:123]
v_mfma_f32_16x16x32_bf16 v[140:143], v[8:11], v[40:43], v[140:143]
v_mfma_f32_16x16x32_bf16 v[160:163], v[12:15], v[40:43], v[160:163]
v_mfma_f32_16x16x32_bf16 v[180:183], v[16:19], v[40:43], v[180:183]
buffer_load_dwordx4 v[100:103], v198, s[16:19], s70 offen offset:1024 sc1
v_mfma_f32_16x16x32_bf16 v[124:127], v[4:7], v[44:47], v[124:127]
v_mfma_f32_16x16x32_bf16 v[144:147], v[8:11], v[44:47], v[144:147]
v_mfma_f32_16x16x32_bf16 v[164:167], v[12:15], v[44:47], v[164:167]
v_mfma_f32_16x16x32_bf16 v[184:187], v[16:19], v[44:47], v[184:187]
buffer_load_dwordx4 v[104:107], v198, s[16:19], s70 offen offset:2048 sc1
v_mfma_f32_16x16x32_bf16 v[128:131], v[4:7], v[48:51], v[128:131]
v_mfma_f32_16x16x32_bf16 v[148:151], v[8:11], v[48:51], v[148:151]
v_mfma_f32_16x16x32_bf16 v[168:171], v[12:15], v[48:51], v[168:171]
v_mfma_f32_16x16x32_bf16 v[188:191], v[16:19], v[48:51], v[188:191]
buffer_load_dwordx4 v[108:111], v198, s[16:19], s70 offen offset:3072 sc1
v_mfma_f32_16x16x32_bf16 v[132:135], v[4:7], v[52:55], v[132:135]
v_mfma_f32_16x16x32_bf16 v[152:155], v[8:11], v[52:55], v[152:155]
v_mfma_f32_16x16x32_bf16 v[172:175], v[12:15], v[52:55], v[172:175]
v_mfma_f32_16x16x32_bf16 v[192:195], v[16:19], v[52:55], v[192:195]
buffer_load_dwordx4 v[112:115], v199, s[16:19], s70 offen sc1
s_add_u32 s70, s70, s71
s_cmp_eq_u32 s79, 12
s_cbranch_scc1 L_drain0
s_waitcnt vmcnt(10)
ds_read_b64_tr_b16 v[4:5], v200 offset:8192
ds_read_b64_tr_b16 v[6:7], v200 offset:8704
ds_read_b64_tr_b16 v[8:9], v201 offset:8192
ds_read_b64_tr_b16 v[10:11], v201 offset:8704
ds_read_b64_tr_b16 v[12:13], v202 offset:8192
ds_read_b64_tr_b16 v[14:15], v202 offset:8704
ds_read_b64_tr_b16 v[16:17], v203 offset:8192
ds_read_b64_tr_b16 v[18:19], v203 offset:8704
s_waitcnt lgkmcnt(8)
s_cmp_lt_u32 s74, s76
s_cbranch_scc0 Ls21
s_add_u32 m0, s7, s87
s_add_u32 s81, s74, s77
buffer_load_dwordx4 v196, s[12:15], s74 offen  lds
s_add_u32 m0, m0, 1024
s_add_u32 s74, s74, s88
buffer_load_dwordx4 v197, s[12:15], s81 offen  lds
s_xor_b32 s88, s88, s89
s_add_u32 s87, s87, 2048
Ls21:
s_cmp_lt_u32 s70, s72
s_cselect_b32 s18, s73, 0
v_mfma_f32_16x16x32_bf16 v[116:119], v[20:23], v[56:59], v[116:119]
v_mfma_f32_16x16x32_bf16 v[136:139], v[24:27], v[56:59], v[136:139]
v_mfma_f32_16x16x32_bf16 v[156:159], v[28:31], v[56:59], v[156:159]
v_mfma_f32_16x16x32_bf16 v[176:179], v[32:35], v[56:59], v[176:179]
buffer_load_dwordx4 v[36:39], v198, s[16:19], s70 offen offset:0 sc1
v_mfma_f32_16x16x32_bf16 v[120:123], v[20:23], v[60:63], v[120:123]
v_mfma_f32_16x16x32_bf16 v[140:143], v[24:27], v[60:63], v[140:143]
v_mfma_f32_16x16x32_bf16 v[160:163], v[28:31], v[60:63], v[160:163]
v_mfma_f32_16x16x32_bf16 v[180:183], v[32:35], v[60:63], v[180:183]
buffer_load_dwordx4 v[40:43], v198, s[16:19], s70 offen offset:1024 sc1
v_mfma_f32_16x16x32_bf16 v[124:127], v[20:23], v[64:67], v[124:127]
v_mfma_f32_16x16x32_bf16 v[144:147], v[24:27], v[64:67], v[144:147]
v_mfma_f32_16x16x32_bf16 v[164:167], v[28:31], v[64:67], v[164:167]
v_mfma_f32_16x16x32_bf16 v[184:187], v[32:35], v[64:67], v[184:187]
buffer_load_dwordx4 v[44:47], v198, s[16:19], s70 offen offset:2048 sc1
v_mfma_f32_16x16x32_bf16 v[128:131], v[20:23], v[68:71], v[128:131]
v_mfma_f32_16x16x32_bf16 v[148:151], v[24:27], v[68:71], v[148:151]
v_mfma_f32_16x16x32_bf16 v[168:171], v[28:31], v[68:71], v[168:171]
v_mfma_f32_16x16x32_bf16 v[188:191], v[32:35], v[68:71], v[188:191]
buffer_load_dwordx4 v[48:51], v198, s[16:19], s70 offen offset:3072 sc1
v_mfma_f32_16x16x32_bf16 v[132:135], v[20:23], v[72:75], v[132:135]
v_mfma_f32_16x16x32_bf16 v[152:155], v[24:27], v[72:75], v[152:155]
v_mfma_f32_16x16x32_bf16 v[172:175], v[28:31], v[72:75], v[172:175]
v_mfma_f32_16x16x32_bf16 v[192:195], v[32:35], v[72:75], v[192:195]
buffer_load_dwordx4 v[52:55], v199, s[16:19], s70 offen sc1
s_add_u32 s70, s70, s71
s_waitcnt vmcnt(10)
ds_read_b64_tr_b16 v[20:21], v200 offset:12288
ds_read_b64_tr_b16 v[22:23], v200 offset:12800
ds_read_b64_tr_b16 v[24:25], v201 offset:12288
ds_read_b64_tr_b16 v[26:27], v201 offset:12800
ds_read_b64_tr_b16 v[28:29], v202 offset:12288
ds_read_b64_tr_b16 v[30:31], v202 offset:12800
ds_read_b64_tr_b16 v[32:33], v203 offset:12288
ds_read_b64_tr_b16 v[34:35], v203 offset:12800
s_waitcnt lgkmcnt(8)
s_cmp_lt_u32 s74, s76
s_cbranch_scc0 Ls22
s_add_u32 m0, s7, s87
s_add_u32 s81, s74, s77
buffer_load_dwordx4 v196, s[12:15], s74 offen  lds
s_add_u32 m0, m0, 1024
s_add_u32 s74, s74, s88
buffer_load_dwordx4 v197, s[12:15], s81 offen  lds
s_xor_b32 s88, s88, s89
s_add_u32 s87, s87, 2048
Ls22:
s_cmp_lt_u32 s70, s72
s_cselect_b32 s18, s73, 0
v_mfma_f32_16x16x32_bf16 v[116:119], v[4:7], v[76:79], v[116:119]
v_mfma_f32_16x16x32_bf16 v[136:139], v[8:11], v[76:79], v[136:139]
v_mfma_f32_16x16x32_bf16 v[156:159], v[12:15], v[76:79], v[156:159]
v_mfma_f32_16x16x32_bf16 v[176:179], v[16:19], v[76:79], v[176:179]
buffer_load_dwordx4 v[56:59], v198, s[16:19], s70 offen offset:0 sc1
v_mfma_f32_16x16x32_bf16 v[120:123], v[4:7], v[80:83], v[120:123]
v_mfma_f32_16x16x32_bf16 v[140:143], v[8:11], v[80:83], v[140:143]
v_mfma_f32_16x16x32_bf16 v[160:163], v[12:15], v[80:83], v[160:163]
v_mfma_f32_16x16x32_bf16 v[180:183], v[16:19], v[80:83], v[180:183]
buffer_load_dwordx4 v[60:63], v198, s[16:19], s70 offen offset:1024 sc1
v_mfma_f32_16x16x32_bf16 v[124:127], v[4:7], v[84:87], v[124:127]
v_mfma_f32_16x16x32_bf16 v[144:147], v[8:11], v[84:87], v[144:147]
v_mfma_f32_16x16x32_bf16 v[164:167], v[12:15], v[84:87], v[164:167]
v_mfma_f32_16x16x32_bf16 v[184:187], v[16:19], v[84:87], v[184:187]
buffer_load_dwordx4 v[64:67], v198, s[16:19], s70 offen offset:2048 sc1
v_mfma_f32_16x16x32_bf16 v[128:131], v[4:7], v[88:91], v[128:131]
v_mfma_f32_16x16x32_bf16 v[148:151], v[8:11], v[88:91], v[148:151]
v_mfma_f32_16x16x32_bf16 v[168:171], v[12:15], v[88:91], v[168:171]
v_mfma_f32_16x16x32_bf16 v[188:191], v[16:19], v[88:91], v[188:191]
buffer_load_dwordx4 v[68:71], v198, s[16:19], s70 offen offset:3072 sc1
v_mfma_f32_16x16x32_bf16 v[132:135], v[4:7], v[92:95], v[132:135]
v_mfma_f32_16x16x32_bf16 v[152:155], v[8:11], v[92:95], v[152:155]
v_mfma_f32_16x16x32_bf16 v[172:175], v[12:15], v[92:95], v[172:175]
v_mfma_f32_16x16x32_bf16 v[192:195], v[16:19], v[92:95], v[192:195]
buffer_load_dwordx4 v[72:75], v199, s[16:19], s70 offen sc1
s_add_u32 s70, s70, s71
s_cmp_eq_u32 s79, 9
s_cbranch_scc1 L_drain1
s_cmp_eq_u32 s80, 0
s_cbranch_scc1 Lc23
s_mov_b32 s69, 0
Lw24:
ds_read_b32 v204, v230 offset:36
s_add_u32 s69, s69, 1
s_waitcnt lgkmcnt(0)
v_readfirstlane_b32 s68, v204
s_cmp_ge_u32 s68, s80
s_cbranch_scc1 Le25
s_cmp_lt_u32 s69, 2097152
s_cbranch_scc1 Lw24
Le25:
s_mov_b32 s80, 0
Lc23:
s_cmp_lg_u32 s79, 5
s_cbranch_scc1 Lc26
s_mov_b32 s69, 0
Lw27:
ds_read_b32 v204, v230 offset:44
s_add_u32 s69, s69, 1
s_waitcnt lgkmcnt(0)
v_readfirstlane_b32 s68, v204
s_cmp_ge_u32 s68, 2
s_cbranch_scc1 Le28
s_cmp_lt_u32 s69, 2097152
s_cbranch_scc1 Lw27
Le28:
Lc26:
s_waitcnt vmcnt(10)
v_xor_b32 v200, 0x4000, v200
v_xor_b32 v201, 0x4000, v201
v_xor_b32 v202, 0x4000, v202
v_xor_b32 v203, 0x4000, v203
ds_read_b64_tr_b16 v[4:5], v200 offset:0
ds_read_b64_tr_b16 v[6:7], v200 offset:512
ds_read_b64_tr_b16 v[8:9], v201 offset:0
ds_read_b64_tr_b16 v[10:11], v201 offset:512
ds_read_b64_tr_b16 v[12:13], v202 offset:0
ds_read_b64_tr_b16 v[14:15], v202 offset:512
ds_read_b64_tr_b16 v[16:17], v203 offset:0
ds_read_b64_tr_b16 v[18:19], v203 offset:512
s_waitcnt lgkmcnt(8)
s_cmp_lt_u32 s74, s76
s_cbranch_scc0 Ls29
s_add_u32 m0, s7, s87
s_add_u32 s81, s74, s77
buffer_load_dwordx4 v196, s[12:15], s74 offen  lds
s_add_u32 m0, m0, 1024
s_add_u32 s74, s74, s88
buffer_load_dwordx4 v197, s[12:15], s81 offen  lds
s_xor_b32 s88, s88, s89
s_add_u32 s87, s87, 2048
Ls29:
s_cmp_lt_u32 s70, s72
s_cselect_b32 s18, s73, 0
v_mfma_f32_16x16x32_bf16 v[116:119], v[20:23], v[96:99], v[116:119]
v_mfma_f32_16x16x32_bf16 v[136:139], v[24:27], v[96:99], v[136:139]
v_mfma_f32_16x16x32_bf16 v[156:159], v[28:31], v[96:99], v[156:159]
v_mfma_f32_16x16x32_bf16 v[176:179], v[32:35], v[96:99], v[176:179]
buffer_load_dwordx4 v[76:79], v198, s[16:19], s70 offen offset:0 sc1
v_mfma_f32_16x16x32_bf16 v[120:123], v[20:23], v[100:103], v[120:123]
v_mfma_f32_16x16x32_bf16 v[140:143], v[24:27], v[100:103], v[140:143]
v_mfma_f32_16x16x32_bf16 v[160:163], v[28:31], v[100:103], v[160:163]
v_mfma_f32_16x16x32_bf16 v[180:183], v[32:35], v[100:103], v[180:183]
buffer_load_dwordx4 v[80:83], v198, s[16:19], s70 offen offset:1024 sc1
v_mfma_f32_16x16x32_bf16 v[124:127], v[20:23], v[104:107], v[124:127]
v_mfma_f32_16x16x32_bf16 v[144:147], v[24:27], v[104:107], v[144:147]
v_mfma_f32_16x16x32_bf16 v[164:167], v[28:31], v[104:107], v[164:167]
v_mfma_f32_16x16x32_bf16 v[184:187], v[32:35], v[104:107], v[184:187]
buffer_load_dwordx4 v[84:87], v198, s[16:19], s70 offen offset:2048 sc1
v_mfma_f32_16x16x32_bf16 v[128:131], v[20:23], v[108:111], v[128:131]
v_mfma_f32_16x16x32_bf16 v[148:151], v[24:27], v[108:111], v[148:151]
v_mfma_f32_16x16x32_bf16 v[168:171], v[28:31], v[108:111], v[168:171]
v_mfma_f32_16x16x32_bf16 v[188:191], v[32:35], v[108:111], v[188:191]
buffer_load_dwordx4 v[88:91], v198, s[16:19], s70 offen offset:3072 sc1
v_mfma_f32_16x16x32_bf16 v[132:135], v[20:23], v[112:115], v[132:135]
v_mfma_f32_16x16x32_bf16 v[152:155], v[24:27], v[112:115], v[152:155]
v_mfma_f32_16x16x32_bf16 v[172:175], v[28:31], v[112:115], v[172:175]
v_mfma_f32_16x16x32_bf16 v[192:195], v[32:35], v[112:115], v[192:195]
buffer_load_dwordx4 v[92:95], v199, s[16:19], s70 offen sc1
s_add_u32 s70, s70, s71
s_cmp_eq_u32 s4, 0
s_cbranch_scc1 Lr30
s_mov_b64 exec, 1
v_mov_b32 v204, 1
ds_add_u32 v230, v204 offset:20
s_mov_b64 exec, -1
Lr30:
s_add_u32 s79, s79, 4
s_branch L_loop
L_drain0:
s_mov_b64 exec, 1
v_mov_b32 v204, 1
ds_add_u32 v230, v204 offset:56
s_mov_b64 exec, -1
s_mov_b64 exec, 1
v_mov_b32 v204, 1
ds_add_u32 v230, v204 offset:20
s_mov_b64 exec, -1
s_waitcnt vmcnt(10)
ds_read_b64_tr_b16 v[4:5], v200 offset:8192
ds_read_b64_tr_b16 v[6:7], v200 offset:8704
ds_read_b64_tr_b16 v[8:9], v201 offset:8192
ds_read_b64_tr_b16 v[10:11], v201 offset:8704
ds_read_b64_tr_b16 v[12:13], v202 offset:8192
ds_read_b64_tr_b16 v[14:15], v202 offset:8704
ds_read_b64_tr_b16 v[16:17], v203 offset:8192
ds_read_b64_tr_b16 v[18:19], v203 offset:8704
s_waitcnt lgkmcnt(8)
v_mfma_f32_16x16x32_bf16 v[116:119], v[20:23], v[56:59], v[116:119]
v_mfma_f32_16x16x32_bf16 v[136:139], v[24:27], v[56:59], v[136:139]
v_mfma_f32_16x16x32_bf16 v[156:159], v[28:31], v[56:59], v[156:159]
v_mfma_f32_16x16x32_bf16 v[176:179], v[32:35], v[56:59], v[176:179]
v_mfma_f32_16x16x32_bf16 v[120:123], v[20:23], v[60:63], v[120:123]
v_mfma_f32_16x16x32_bf16 v[140:143], v[24:27], v[60:63], v[140:143]
v_mfma_f32_16x16x32_bf16 v[160:163], v[28:31], v[60:63], v[160:163]
v_mfma_f32_16x16x32_bf16 v[180:183], v[32:35], v[60:63], v[180:183]
v_mfma_f32_16x16x32_bf16 v[124:127], v[20:23], v[64:67], v[124:127]
v_mfma_f32_16x16x32_bf16 v[144:147], v[24:27], v[64:67], v[144:147]
v_mfma_f32_16x16x32_bf16 v[164:167], v[28:31], v[64:67], v[164:167]
v_mfma_f32_16x16x32_bf16 v[184:187], v[32:35], v[64:67], v[184:187]
v_mfma_f32_16x16x32_bf16 v[128:131], v[20:23], v[68:71], v[128:131]
v_mfma_f32_16x16x32_bf16 v[148:151], v[24:27], v[68:71], v[148:151]
v_mfma_f32_16x16x32_bf16 v[168:171], v[28:31], v[68:71], v[168:171]
v_mfma_f32_16x16x32_bf16 v[188:191], v[32:35], v[68:71], v[188:191]
v_mfma_f32_16x16x32_bf16 v[132:135], v[20:23], v[72:75], v[132:135]
v_mfma_f32_16x16x32_bf16 v[152:155], v[24:27], v[72:75], v[152:155]
v_mfma_f32_16x16x32_bf16 v[172:175], v[28:31], v[72:75], v[172:175]
v_mfma_f32_16x16x32_bf16 v[192:195], v[32:35], v[72:75], v[192:195]
s_waitcnt vmcnt(5)
ds_read_b64_tr_b16 v[20:21], v200 offset:12288
ds_read_b64_tr_b16 v[22:23], v200 offset:12800
ds_read_b64_tr_b16 v[24:25], v201 offset:12288
ds_read_b64_tr_b16 v[26:27], v201 offset:12800
ds_read_b64_tr_b16 v[28:29], v202 offset:12288
ds_read_b64_tr_b16 v[30:31], v202 offset:12800
ds_read_b64_tr_b16 v[32:33], v203 offset:12288
ds_read_b64_tr_b16 v[34:35], v203 offset:12800
s_waitcnt lgkmcnt(8)
v_mfma_f32_16x16x32_bf16 v[116:119], v[4:7], v[76:79], v[116:119]
v_mfma_f32_16x16x32_bf16 v[136:139], v[8:11], v[76:79], v[136:139]
v_mfma_f32_16x16x32_bf16 v[156:159], v[12:15], v[76:79], v[156:159]
v_mfma_f32_16x16x32_bf16 v[176:179], v[16:19], v[76:79], v[176:179]
v_mfma_f32_16x16x32_bf16 v[120:123], v[4:7], v[80:83], v[120:123]
v_mfma_f32_16x16x32_bf16 v[140:143], v[8:11], v[80:83], v[140:143]
v_mfma_f32_16x16x32_bf16 v[160:163], v[12:15], v[80:83], v[160:163]
v_mfma_f32_16x16x32_bf16 v[180:183], v[16:19], v[80:83], v[180:183]
v_mfma_f32_16x16x32_bf16 v[124:127], v[4:7], v[84:87], v[124:127]
v_mfma_f32_16x16x32_bf16 v[144:147], v[8:11], v[84:87], v[144:147]
v_mfma_f32_16x16x32_bf16 v[164:167], v[12:15], v[84:87], v[164:167]
v_mfma_f32_16x16x32_bf16 v[184:187], v[16:19], v[84:87], v[184:187]
v_mfma_f32_16x16x32_bf16 v[128:131], v[4:7], v[88:91], v[128:131]
v_mfma_f32_16x16x32_bf16 v[148:151], v[8:11], v[88:91], v[148:151]
v_mfma_f32_16x16x32_bf16 v[168:171], v[12:15], v[88:91], v[168:171]
v_mfma_f32_16x16x32_bf16 v[188:191], v[16:19], v[88:91], v[188:191]
v_mfma_f32_16x16x32_bf16 v[132:135], v[4:7], v[92:95], v[132:135]
v_mfma_f32_16x16x32_bf16 v[152:155], v[8:11], v[92:95], v[152:155]
v_mfma_f32_16x16x32_bf16 v[172:175], v[12:15], v[92:95], v[172:175]
v_mfma_f32_16x16x32_bf16 v[192:195], v[16:19], v[92:95], v[192:195]
v_add_u32 v204, s7, v198
s_waitcnt vmcnt(0) lgkmcnt(0)
v_mfma_f32_16x16x32_bf16 v[136:139], v[24:27], v[96:99], v[136:139]
v_mfma_f32_16x16x32_bf16 v[156:159], v[28:31], v[96:99], v[156:159]
v_mfma_f32_16x16x32_bf16 v[176:179], v[32:35], v[96:99], v[176:179]
v_mfma_f32_16x16x32_bf16 v[140:143], v[24:27], v[100:103], v[140:143]
v_mfma_f32_16x16x32_bf16 v[160:163], v[28:31], v[100:103], v[160:163]
v_mfma_f32_16x16x32_bf16 v[180:183], v[32:35], v[100:103], v[180:183]
v_mfma_f32_16x16x32_bf16 v[144:147], v[24:27], v[104:107], v[144:147]
v_mfma_f32_16x16x32_bf16 v[164:167], v[28:31], v[104:107], v[164:167]
v_mfma_f32_16x16x32_bf16 v[184:187], v[32:35], v[104:107], v[184:187]
ds_write_b128 v204, v[136:139] offset:16384
ds_write_b128 v204, v[156:159] offset:21504
ds_write_b128 v204, v[176:179] offset:26624
v_mfma_f32_16x16x32_bf16 v[148:151], v[24:27], v[108:111], v[148:151]
v_mfma_f32_16x16x32_bf16 v[168:171], v[28:31], v[108:111], v[168:171]
v_mfma_f32_16x16x32_bf16 v[188:191], v[32:35], v[108:111], v[188:191]
ds_write_b128 v204, v[140:143] offset:17408
ds_write_b128 v204, v[160:163] offset:22528
ds_write_b128 v204, v[180:183] offset:27648
v_mfma_f32_16x16x32_bf16 v[152:155], v[24:27], v[112:115], v[152:155]
v_mfma_f32_16x16x32_bf16 v[172:175], v[28:31], v[112:115], v[172:175]
v_mfma_f32_16x16x32_bf16 v[192:195], v[32:35], v[112:115], v[192:195]
ds_write_b128 v204, v[144:147] offset:18432
ds_write_b128 v204, v[164:167] offset:23552
ds_write_b128 v204, v[184:187] offset:28672
v_mfma_f32_16x16x32_bf16 v[116:119], v[20:23], v[96:99], v[116:119]
v_mfma_f32_16x16x32_bf16 v[120:123], v[20:23], v[100:103], v[120:123]
v_mfma_f32_16x16x32_bf16 v[124:127], v[20:23], v[104:107], v[124:127]
v_mfma_f32_16x16x32_bf16 v[128:131], v[20:23], v[108:111], v[128:131]
v_mfma_f32_16x16x32_bf16 v[132:135], v[20:23], v[112:115], v[132:135]
ds_write_b128 v204, v[148:151] offset:19456
ds_write_b128 v204, v[168:171] offset:24576
ds_write_b128 v204, v[188:191] offset:29696
ds_write_b128 v204, v[152:155] offset:20480
ds_write_b128 v204, v[172:175] offset:25600
ds_write_b128 v204, v[192:195] offset:30720
s_branch L_drained
L_drain1:
s_mov_b32 s69, 0
Lw31:
ds_read_b32 v204, v230 offset:48
s_add_u32 s69, s69, 1
s_waitcnt lgkmcnt(0)
v_readfirstlane_b32 s68, v204
s_cmp_ge_u32 s68, 2
s_cbranch_scc1 Le32
s_cmp_lt_u32 s69, 2097152
s_cbranch_scc1 Lw31
Le32:
s_waitcnt vmcnt(10)
v_xor_b32 v200, 0x4000, v200
v_xor_b32 v201, 0x4000, v201
v_xor_b32 v202, 0x4000, v202
v_xor_b32 v203, 0x4000, v203
ds_read_b64_tr_b16 v[4:5], v200 offset:0
ds_read_b64_tr_b16 v[6:7], v200 offset:512
ds_read_b64_tr_b16 v[8:9], v201 offset:0
ds_read_b64_tr_b16 v[10:11], v201 offset:512
ds_read_b64_tr_b16 v[12:13], v202 offset:0
ds_read_b64_tr_b16 v[14:15], v202 offset:512
ds_read_b64_tr_b16 v[16:17], v203 offset:0
ds_read_b64_tr_b16 v[18:19], v203 offset:512
s_waitcnt lgkmcnt(8)
v_mfma_f32_16x16x32_bf16 v[116:119], v[20:23], v[96:99], v[116:119]
v_mfma_f32_16x16x32_bf16 v[136:139], v[24:27], v[96:99], v[136:139]
v_mfma_f32_16x16x32_bf16 v[156:159], v[28:31], v[96:99], v[156:159]
v_mfma_f32_16x16x32_bf16 v[176:179], v[32:35], v[96:99], v[176:179]
v_mfma_f32_16x16x32_bf16 v[120:123], v[20:23], v[100:103], v[120:123]
v_mfma_f32_16x16x32_bf16 v[140:143], v[24:27], v[100:103], v[140:143]
v_mfma_f32_16x16x32_bf16 v[160:163], v[28:31], v[100:103], v[160:163]
v_mfma_f32_16x16x32_bf16 v[180:183], v[32:35], v[100:103], v[180:183]
v_mfma_f32_16x16x32_bf16 v[124:127], v[20:23], v[104:107], v[124:127]
v_mfma_f32_16x16x32_bf16 v[144:147], v[24:27], v[104:107], v[144:147]
v_mfma_f32_16x16x32_bf16 v[164:167], v[28:31], v[104:107], v[164:167]
v_mfma_f32_16x16x32_bf16 v[184:187], v[32:35], v[104:107], v[184:187]
v_mfma_f32_16x16x32_bf16 v[128:131], v[20:23], v[108:111], v[128:131]
v_mfma_f32_16x16x32_bf16 v[148:151], v[24:27], v[108:111], v[148:151]
v_mfma_f32_16x16x32_bf16 v[168:171], v[28:31], v[108:111], v[168:171]
v_mfma_f32_16x16x32_bf16 v[188:191], v[32:35], v[108:111], v[188:191]
v_mfma_f32_16x16x32_bf16 v[132:135], v[20:23], v[112:115], v[132:135]
v_mfma_f32_16x16x32_bf16 v[152:155], v[24:27], v[112:115], v[152:155]
v_mfma_f32_16x16x32_bf16 v[172:175], v[28:31], v[112:115], v[172:175]
v_mfma_f32_16x16x32_bf16 v[192:195], v[32:35], v[112:115], v[192:195]
s_mov_b32 s69, 0
Lw33:
ds_read_b32 v204, v230 offset:28
s_add_u32 s69, s69, 1
s_waitcnt lgkmcnt(0)
v_readfirstlane_b32 s68, v204
s_cmp_ge_u32 s68, 2
s_cbranch_scc1 Le34
s_sleep 1
s_cmp_lt_u32 s69, 2097152
s_cbranch_scc1 Lw33
Le34:
s_mul_i32 s68, s10, 327680
s_lshl_b32 s85, s84, 1
s_add_u32 s68, s68, s85
buffer_load_dwordx2 v[216:217], v229, s[28:31], s68 offen sc1
s_add_u32 s68, s68, 65536
buffer_load_dwordx2 v[218:219], v229, s[28:31], s68 offen sc1
s_add_u32 s68, s68, 65536
buffer_load_dwordx2 v[220:221], v229, s[28:31], s68 offen sc1
s_add_u32 s68, s68, 65536
buffer_load_dwordx2 v[222:223], v229, s[28:31], s68 offen sc1
s_add_u32 s68, s68, 65536
buffer_load_dwordx2 v[224:225], v229, s[28:31], s68 offen sc1
s_waitcnt vmcnt(5)
ds_read_b64_tr_b16 v[20:21], v200 offset:4096
ds_read_b64_tr_b16 v[22:23], v200 offset:4608
ds_read_b64_tr_b16 v[24:25], v201 offset:4096
ds_read_b64_tr_b16 v[26:27], v201 offset:4608
ds_read_b64_tr_b16 v[28:29], v202 offset:4096
ds_read_b64_tr_b16 v[30:31], v202 offset:4608
ds_read_b64_tr_b16 v[32:33], v203 offset:4096
ds_read_b64_tr_b16 v[34:35], v203 offset:4608
s_waitcnt lgkmcnt(8)
v_mfma_f32_16x16x32_bf16 v[116:119], v[4:7], v[36:39], v[116:119]
v_mfma_f32_16x16x32_bf16 v[136:139], v[8:11], v[36:39], v[136:139]
v_mfma_f32_16x16x32_bf16 v[156:159], v[12:15], v[36:39], v[156:159]
v_mfma_f32_16x16x32_bf16 v[176:179], v[16:19], v[36:39], v[176:179]
v_mfma_f32_16x16x32_bf16 v[120:123], v[4:7], v[40:43], v[120:123]
v_mfma_f32_16x16x32_bf16 v[140:143], v[8:11], v[40:43], v[140:143]
v_mfma_f32_16x16x32_bf16 v[160:163], v[12:15], v[40:43], v[160:163]
v_mfma_f32_16x16x32_bf16 v[180:183], v[16:19], v[40:43], v[180:183]
v_mfma_f32_16x16x32_bf16 v[124:127], v[4:7], v[44:47], v[124:127]
v_mfma_f32_16x16x32_bf16 v[144:147], v[8:11], v[44:47], v[144:147]
v_mfma_f32_16x16x32_bf16 v[164:167], v[12:15], v[44:47], v[164:167]
v_mfma_f32_16x16x32_bf16 v[184:187], v[16:19], v[44:47], v[184:187]
v_mfma_f32_16x16x32_bf16 v[128:131], v[4:7], v[48:51], v[128:131]
v_mfma_f32_16x16x32_bf16 v[148:151], v[8:11], v[48:51], v[148:151]
v_mfma_f32_16x16x32_bf16 v[168:171], v[12:15], v[48:51], v[168:171]
v_mfma_f32_16x16x32_bf16 v[188:191], v[16:19], v[48:51], v[188:191]
v_mfma_f32_16x16x32_bf16 v[132:135], v[4:7], v[52:55], v[132:135]
v_mfma_f32_16x16x32_bf16 v[152:155], v[8:11], v[52:55], v[152:155]
v_mfma_f32_16x16x32_bf16 v[172:175], v[12:15], v[52:55], v[172:175]
v_mfma_f32_16x16x32_bf16 v[192:195], v[16:19], v[52:55], v[192:195]
v_add_u32 v204, s7, v198
s_waitcnt lgkmcnt(0)
v_mfma_f32_16x16x32_bf16 v[136:139], v[24:27], v[56:59], v[136:139]
v_mfma_f32_16x16x32_bf16 v[156:159], v[28:31], v[56:59], v[156:159]
v_mfma_f32_16x16x32_bf16 v[176:179], v[32:35], v[56:59], v[176:179]
v_mfma_f32_16x16x32_bf16 v[140:143], v[24:27], v[60:63], v[140:143]
v_mfma_f32_16x16x32_bf16 v[160:163], v[28:31], v[60:63], v[160:163]
v_mfma_f32_16x16x32_bf16 v[180:183], v[32:35], v[60:63], v[180:183]
v_mfma_f32_16x16x32_bf16 v[144:147], v[24:27], v[64:67], v[144:147]
v_mfma_f32_16x16x32_bf16 v[164:167], v[28:31], v[64:67], v[164:167]
v_mfma_f32_16x16x32_bf16 v[184:187], v[32:35], v[64:67], v[184:187]
ds_write_b128 v204, v[136:139] offset:16384
ds_write_b128 v204, v[156:159] offset:21504
ds_write_b128 v204, v[176:179] offset:26624
v_mfma_f32_16x16x32_bf16 v[148:151], v[24:27], v[68:71], v[148:151]
v_mfma_f32_16x16x32_bf16 v[168:171], v[28:31], v[68:71], v[168:171]
v_mfma_f32_16x16x32_bf16 v[188:191], v[32:35], v[68:71], v[188:191]
ds_write_b128 v204, v[140:143] offset:17408
ds_write_b128 v204, v[160:163] offset:22528
ds_write_b128 v204, v[180:183] offset:27648
v_mfma_f32_16x16x32_bf16 v[152:155], v[24:27], v[72:75], v[152:155]
v_mfma_f32_16x16x32_bf16 v[172:175], v[28:31], v[72:75], v[172:175]
v_mfma_f32_16x16x32_bf16 v[192:195], v[32:35], v[72:75], v[192:195]
ds_write_b128 v204, v[144:147] offset:18432
ds_write_b128 v204, v[164:167] offset:23552
ds_write_b128 v204, v[184:187] offset:28672
v_mfma_f32_16x16x32_bf16 v[116:119], v[20:23], v[56:59], v[116:119]
v_mfma_f32_16x16x32_bf16 v[120:123], v[20:23], v[60:63], v[120:123]
v_mfma_f32_16x16x32_bf16 v[124:127], v[20:23], v[64:67], v[124:127]
v_mfma_f32_16x16x32_bf16 v[128:131], v[20:23], v[68:71], v[128:131]
v_mfma_f32_16x16x32_bf16 v[132:135], v[20:23], v[72:75], v[132:135]
ds_write_b128 v204, v[148:151] offset:19456
ds_write_b128 v204, v[168:171] offset:24576
ds_write_b128 v204, v[188:191] offset:29696
ds_write_b128 v204, v[152:155] offset:20480
ds_write_b128 v204, v[172:175] offset:25600
ds_write_b128 v204, v[192:195] offset:30720
L_drained:
s_mov_b64 exec, 1
v_mov_b32 v4, 1
ds_add_u32 v230, v4 offset:0
s_mov_b64 exec, -1
s_sub_u32 s68, s3, 1
s_and_b32 s68, s68, 3
s_lshl_b32 s68, s68, 15
v_add_u32 v5, s68, v198
s_sub_u32 s68, s3, 2
s_and_b32 s68, s68, 3
s_lshl_b32 s68, s68, 15
v_add_u32 v6, s68, v198
s_sub_u32 s68, s3, 3
s_and_b32 s68, s68, 3
s_lshl_b32 s68, s68, 15
v_add_u32 v7, s68, v198
s_add_u32 s5, s5, 4
s_cmp_lg_u32 s4, 0
s_cbranch_scc1 L_end2
s_branch L_xchg
L_end2:
s_waitcnt vmcnt(0)
v_lshlrev_b32 v12, 16, v216
v_and_b32 v13, 0xffff0000, v216
v_lshlrev_b32 v14, 16, v217
v_and_b32 v15, 0xffff0000, v217
v_lshlrev_b32 v16, 16, v218
v_and_b32 v17, 0xffff0000, v218
v_lshlrev_b32 v18, 16, v219
v_and_b32 v19, 0xffff0000, v219
v_lshlrev_b32 v20, 16, v220
v_and_b32 v21, 0xffff0000, v220
v_lshlrev_b32 v22, 16, v221
v_and_b32 v23, 0xffff0000, v221
v_lshlrev_b32 v24, 16, v222
v_and_b32 v25, 0xffff0000, v222
v_lshlrev_b32 v26, 16, v223
v_and_b32 v27, 0xffff0000, v223
v_lshlrev_b32 v28, 16, v224
v_and_b32 v29, 0xffff0000, v224
v_lshlrev_b32 v30, 16, v225
v_and_b32 v31, 0xffff0000, v225
v_mul_f32 v12, v12, v208
v_mul_f32 v13, v13, v210
v_mul_f32 v14, v14, v212
v_mul_f32 v15, v15, v214
v_mul_f32 v16, v16, v208
v_mul_f32 v17, v17, v210
v_mul_f32 v18, v18, v212
v_mul_f32 v19, v19, v214
v_mul_f32 v20, v20, v208
v_mul_f32 v21, v21, v210
v_mul_f32 v22, v22, v212
v_mul_f32 v23, v23, v214
v_mul_f32 v24, v24, v208
v_mul_f32 v25, v25, v210
v_mul_f32 v26, v26, v212
v_mul_f32 v27, v27, v214
v_mul_f32 v28, v28, v208
v_mul_f32 v29, v29, v210
v_mul_f32 v30, v30, v212
v_mul_f32 v31, v31, v214
v_cvt_pk_bf16_f32 v12, v12, v13
v_cvt_pk_bf16_f32 v14, v14, v15
v_cvt_pk_bf16_f32 v16, v16, v17
v_cvt_pk_bf16_f32 v18, v18, v19
v_cvt_pk_bf16_f32 v20, v20, v21
v_cvt_pk_bf16_f32 v22, v22, v23
v_cvt_pk_bf16_f32 v24, v24, v25
v_cvt_pk_bf16_f32 v26, v26, v27
v_cvt_pk_bf16_f32 v28, v28, v29
v_cvt_pk_bf16_f32 v30, v30, v31
v_and_b32 v13, 0xffff0000, v12
v_lshlrev_b32 v12, 16, v12
v_and_b32 v15, 0xffff0000, v14
v_lshlrev_b32 v14, 16, v14
v_and_b32 v17, 0xffff0000, v16
v_lshlrev_b32 v16, 16, v16
v_and_b32 v19, 0xffff0000, v18
v_lshlrev_b32 v18, 16, v18
v_and_b32 v21, 0xffff0000, v20
v_lshlrev_b32 v20, 16, v20
v_and_b32 v23, 0xffff0000, v22
v_lshlrev_b32 v22, 16, v22
v_and_b32 v25, 0xffff0000, v24
v_lshlrev_b32 v24, 16, v24
v_and_b32 v27, 0xffff0000, v26
v_lshlrev_b32 v26, 16, v26
v_and_b32 v29, 0xffff0000, v28
v_lshlrev_b32 v28, 16, v28
v_and_b32 v31, 0xffff0000, v30
v_lshlrev_b32 v30, 16, v30
L_xchg:
s_mov_b32 s69, 0
Lw35:
ds_read_b32 v4, v230 offset:0
s_add_u32 s69, s69, 1
s_waitcnt lgkmcnt(0)
v_readfirstlane_b32 s68, v4
s_cmp_ge_u32 s68, s5
s_cbranch_scc1 Le36
s_cmp_lt_u32 s69, 2097152
s_cbranch_scc1 Lw35
Le36:
ds_read_b128 v[36:39], v5 offset:16384
ds_read_b128 v[40:43], v5 offset:17408
ds_read_b128 v[44:47], v5 offset:18432
ds_read_b128 v[48:51], v5 offset:19456
ds_read_b128 v[52:55], v5 offset:20480
ds_read_b128 v[56:59], v6 offset:21504
ds_read_b128 v[60:63], v6 offset:22528
ds_read_b128 v[64:67], v6 offset:23552
ds_read_b128 v[68:71], v6 offset:24576
ds_read_b128 v[72:75], v6 offset:25600
ds_read_b128 v[76:79], v7 offset:26624
ds_read_b128 v[80:83], v7 offset:27648
ds_read_b128 v[84:87], v7 offset:28672
ds_read_b128 v[88:91], v7 offset:29696
ds_read_b128 v[92:95], v7 offset:30720
s_waitcnt lgkmcnt(10)
v_pk_add_f32 v[116:117], v[116:117], v[36:37]
v_pk_add_f32 v[118:119], v[118:119], v[38:39]
v_pk_add_f32 v[120:121], v[120:121], v[40:41]
v_pk_add_f32 v[122:123], v[122:123], v[42:43]
v_pk_add_f32 v[124:125], v[124:125], v[44:45]
v_pk_add_f32 v[126:127], v[126:127], v[46:47]
v_pk_add_f32 v[128:129], v[128:129], v[48:49]
v_pk_add_f32 v[130:131], v[130:131], v[50:51]
v_pk_add_f32 v[132:133], v[132:133], v[52:53]
v_pk_add_f32 v[134:135], v[134:135], v[54:55]
s_waitcnt lgkmcnt(5)
v_pk_add_f32 v[116:117], v[116:117], v[56:57]
v_pk_add_f32 v[118:119], v[118:119], v[58:59]
v_pk_add_f32 v[120:121], v[120:121], v[60:61]
v_pk_add_f32 v[122:123], v[122:123], v[62:63]
v_pk_add_f32 v[124:125], v[124:125], v[64:65]
v_pk_add_f32 v[126:127], v[126:127], v[66:67]
v_pk_add_f32 v[128:129], v[128:129], v[68:69]
v_pk_add_f32 v[130:131], v[130:131], v[70:71]
v_pk_add_f32 v[132:133], v[132:133], v[72:73]
v_pk_add_f32 v[134:135], v[134:135], v[74:75]
s_waitcnt lgkmcnt(0)
v_pk_add_f32 v[116:117], v[116:117], v[76:77]
v_pk_add_f32 v[118:119], v[118:119], v[78:79]
v_pk_add_f32 v[120:121], v[120:121], v[80:81]
v_pk_add_f32 v[122:123], v[122:123], v[82:83]
v_pk_add_f32 v[124:125], v[124:125], v[84:85]
v_pk_add_f32 v[126:127], v[126:127], v[86:87]
v_pk_add_f32 v[128:129], v[128:129], v[88:89]
v_pk_add_f32 v[130:131], v[130:131], v[90:91]
v_pk_add_f32 v[132:133], v[132:133], v[92:93]
v_pk_add_f32 v[134:135], v[134:135], v[94:95]
v_lshlrev_b32 v8, 16, v206
v_and_b32 v9, 0xffff0000, v206
v_lshlrev_b32 v10, 16, v207
v_and_b32 v11, 0xffff0000, v207
v_cvt_pk_bf16_f32 v36, v116, v117
v_cvt_pk_bf16_f32 v38, v118, v119
v_cvt_pk_bf16_f32 v40, v120, v121
v_cvt_pk_bf16_f32 v42, v122, v123
v_cvt_pk_bf16_f32 v44, v124, v125
v_cvt_pk_bf16_f32 v46, v126, v127
v_cvt_pk_bf16_f32 v48, v128, v129
v_cvt_pk_bf16_f32 v50, v130, v131
v_cvt_pk_bf16_f32 v52, v132, v133
v_cvt_pk_bf16_f32 v54, v134, v135
v_and_b32 v37, 0xffff0000, v36
v_lshlrev_b32 v36, 16, v36
v_and_b32 v39, 0xffff0000, v38
v_lshlrev_b32 v38, 16, v38
v_and_b32 v41, 0xffff0000, v40
v_lshlrev_b32 v40, 16, v40
v_and_b32 v43, 0xffff0000, v42
v_lshlrev_b32 v42, 16, v42
v_and_b32 v45, 0xffff0000, v44
v_lshlrev_b32 v44, 16, v44
v_and_b32 v47, 0xffff0000, v46
v_lshlrev_b32 v46, 16, v46
v_and_b32 v49, 0xffff0000, v48
v_lshlrev_b32 v48, 16, v48
v_and_b32 v51, 0xffff0000, v50
v_lshlrev_b32 v50, 16, v50
v_and_b32 v53, 0xffff0000, v52
v_lshlrev_b32 v52, 16, v52
v_and_b32 v55, 0xffff0000, v54
v_lshlrev_b32 v54, 16, v54
v_pk_add_f32 v[36:37], v[36:37], v[8:9]
v_pk_add_f32 v[38:39], v[38:39], v[10:11]
v_pk_add_f32 v[40:41], v[40:41], v[8:9]
v_pk_add_f32 v[42:43], v[42:43], v[10:11]
v_pk_add_f32 v[44:45], v[44:45], v[8:9]
v_pk_add_f32 v[46:47], v[46:47], v[10:11]
v_pk_add_f32 v[48:49], v[48:49], v[8:9]
v_pk_add_f32 v[50:51], v[50:51], v[10:11]
v_pk_add_f32 v[52:53], v[52:53], v[8:9]
v_pk_add_f32 v[54:55], v[54:55], v[10:11]
v_cvt_pk_bf16_f32 v36, v36, v37
v_cvt_pk_bf16_f32 v38, v38, v39
v_cvt_pk_bf16_f32 v40, v40, v41
v_cvt_pk_bf16_f32 v42, v42, v43
v_cvt_pk_bf16_f32 v44, v44, v45
v_cvt_pk_bf16_f32 v46, v46, v47
v_cvt_pk_bf16_f32 v48, v48, v49
v_cvt_pk_bf16_f32 v50, v50, v51
v_cvt_pk_bf16_f32 v52, v52, v53
v_cvt_pk_bf16_f32 v54, v54, v55
v_and_b32 v37, 0xffff0000, v36
v_lshlrev_b32 v36, 16, v36
v_and_b32 v39, 0xffff0000, v38
v_lshlrev_b32 v38, 16, v38
v_and_b32 v41, 0xffff0000, v40
v_lshlrev_b32 v40, 16, v40
v_and_b32 v43, 0xffff0000, v42
v_lshlrev_b32 v42, 16, v42
v_and_b32 v45, 0xffff0000, v44
v_lshlrev_b32 v44, 16, v44
v_and_b32 v47, 0xffff0000, v46
v_lshlrev_b32 v46, 16, v46
v_and_b32 v49, 0xffff0000, v48
v_lshlrev_b32 v48, 16, v48
v_and_b32 v51, 0xffff0000, v50
v_lshlrev_b32 v50, 16, v50
v_and_b32 v53, 0xffff0000, v52
v_lshlrev_b32 v52, 16, v52
v_and_b32 v55, 0xffff0000, v54
v_lshlrev_b32 v54, 16, v54
s_cmp_lg_u32 s4, 0
s_cbranch_scc1 L_final
s_mov_b32 s68, 0xbdd2d3e8
s_mov_b32 s69, s68
v_mov_b32 v6, 0xc0135761
v_mov_b32 v7, v6
v_pk_mul_f32 v[56:57], v[36:37], v[36:37]
v_pk_mul_f32 v[58:59], v[38:39], v[38:39]
v_pk_mul_f32 v[60:61], v[40:41], v[40:41]
v_pk_mul_f32 v[62:63], v[42:43], v[42:43]
v_pk_mul_f32 v[64:65], v[44:45], v[44:45]
v_pk_mul_f32 v[66:67], v[46:47], v[46:47]
v_pk_mul_f32 v[68:69], v[48:49], v[48:49]
v_pk_mul_f32 v[70:71], v[50:51], v[50:51]
v_pk_mul_f32 v[72:73], v[52:53], v[52:53]
v_pk_mul_f32 v[74:75], v[54:55], v[54:55]
v_pk_fma_f32 v[56:57], v[56:57], s[68:69], v[6:7]
v_pk_fma_f32 v[58:59], v[58:59], s[68:69], v[6:7]
v_pk_fma_f32 v[60:61], v[60:61], s[68:69], v[6:7]
v_pk_fma_f32 v[62:63], v[62:63], s[68:69], v[6:7]
v_pk_fma_f32 v[64:65], v[64:65], s[68:69], v[6:7]
v_pk_fma_f32 v[66:67], v[66:67], s[68:69], v[6:7]
v_pk_fma_f32 v[68:69], v[68:69], s[68:69], v[6:7]
v_pk_fma_f32 v[70:71], v[70:71], s[68:69], v[6:7]
v_pk_fma_f32 v[72:73], v[72:73], s[68:69], v[6:7]
v_pk_fma_f32 v[74:75], v[74:75], s[68:69], v[6:7]
v_pk_mul_f32 v[56:57], v[56:57], v[36:37]
v_pk_mul_f32 v[58:59], v[58:59], v[38:39]
v_pk_mul_f32 v[60:61], v[60:61], v[40:41]
v_pk_mul_f32 v[62:63], v[62:63], v[42:43]
v_pk_mul_f32 v[64:65], v[64:65], v[44:45]
v_pk_mul_f32 v[66:67], v[66:67], v[46:47]
v_pk_mul_f32 v[68:69], v[68:69], v[48:49]
v_pk_mul_f32 v[70:71], v[70:71], v[50:51]
v_pk_mul_f32 v[72:73], v[72:73], v[52:53]
v_pk_mul_f32 v[74:75], v[74:75], v[54:55]
v_exp_f32 v56, v56
v_exp_f32 v57, v57
v_exp_f32 v58, v58
v_exp_f32 v59, v59
v_exp_f32 v60, v60
v_exp_f32 v61, v61
v_exp_f32 v62, v62
v_exp_f32 v63, v63
v_exp_f32 v64, v64
v_exp_f32 v65, v65
v_exp_f32 v66, v66
v_exp_f32 v67, v67
v_exp_f32 v68, v68
v_exp_f32 v69, v69
v_exp_f32 v70, v70
v_exp_f32 v71, v71
v_exp_f32 v72, v72
v_exp_f32 v73, v73
v_exp_f32 v74, v74
v_exp_f32 v75, v75
v_add_f32 v56, 1.0, v56
v_add_f32 v57, 1.0, v57
v_add_f32 v58, 1.0, v58
v_add_f32 v59, 1.0, v59
v_add_f32 v60, 1.0, v60
v_add_f32 v61, 1.0, v61
v_add_f32 v62, 1.0, v62
v_add_f32 v63, 1.0, v63
v_add_f32 v64, 1.0, v64
v_add_f32 v65, 1.0, v65
v_add_f32 v66, 1.0, v66
v_add_f32 v67, 1.0, v67
v_add_f32 v68, 1.0, v68
v_add_f32 v69, 1.0, v69
v_add_f32 v70, 1.0, v70
v_add_f32 v71, 1.0, v71
v_add_f32 v72, 1.0, v72
v_add_f32 v73, 1.0, v73
v_add_f32 v74, 1.0, v74
v_add_f32 v75, 1.0, v75
v_rcp_f32 v56, v56
v_rcp_f32 v57, v57
v_rcp_f32 v58, v58
v_rcp_f32 v59, v59
v_rcp_f32 v60, v60
v_rcp_f32 v61, v61
v_rcp_f32 v62, v62
v_rcp_f32 v63, v63
v_rcp_f32 v64, v64
v_rcp_f32 v65, v65
v_rcp_f32 v66, v66
v_rcp_f32 v67, v67
v_rcp_f32 v68, v68
v_rcp_f32 v69, v69
v_rcp_f32 v70, v70
v_rcp_f32 v71, v71
v_rcp_f32 v72, v72
v_rcp_f32 v73, v73
v_rcp_f32 v74, v74
v_rcp_f32 v75, v75
v_pk_mul_f32 v[56:57], v[56:57], v[36:37]
v_pk_mul_f32 v[58:59], v[58:59], v[38:39]
v_pk_mul_f32 v[60:61], v[60:61], v[40:41]
v_pk_mul_f32 v[62:63], v[62:63], v[42:43]
v_pk_mul_f32 v[64:65], v[64:65], v[44:45]
v_pk_mul_f32 v[66:67], v[66:67], v[46:47]
v_pk_mul_f32 v[68:69], v[68:69], v[48:49]
v_pk_mul_f32 v[70:71], v[70:71], v[50:51]
v_pk_mul_f32 v[72:73], v[72:73], v[52:53]
v_pk_mul_f32 v[74:75], v[74:75], v[54:55]
v_cvt_pk_bf16_f32 v12, v56, v57
v_cvt_pk_bf16_f32 v13, v58, v59
v_cvt_pk_bf16_f32 v14, v60, v61
v_cvt_pk_bf16_f32 v15, v62, v63
v_cvt_pk_bf16_f32 v16, v64, v65
v_cvt_pk_bf16_f32 v17, v66, v67
v_cvt_pk_bf16_f32 v18, v68, v69
v_cvt_pk_bf16_f32 v19, v70, v71
v_cvt_pk_bf16_f32 v20, v72, v73
v_cvt_pk_bf16_f32 v21, v74, v75
v_permlane16_swap_b32 v12, v14
v_permlane16_swap_b32 v13, v15
v_permlane16_swap_b32 v16, v18
v_permlane16_swap_b32 v17, v19
v_permlane16_swap_b32 v20, v22
v_permlane16_swap_b32 v21, v23
buffer_store_dwordx4 v[12:15], v208, s[28:31], s84 offen sc1
buffer_store_dwordx4 v[16:19], v208, s[28:31], s84 offen offset:2048 sc1
s_mov_b32 exec_lo, 0xffff
s_mov_b32 exec_hi, 0xffff
buffer_store_dwordx4 v[20:23], v208, s[28:31], s85 offen sc1
s_mov_b64 exec, -1
s_mov_b64 exec, 1
v_mov_b32 v4, 1
ds_add_u32 v230, v4 offset:60
s_mov_b64 exec, -1
s_and_b32 s10, s9, 7
s_lshl_b32 s11, s8, 2
s_lshr_b32 s68, s9, 3
s_add_u32 s11, s11, s68
s_mov_b32 s12, s56
s_and_b32 s13, s57, 0xffff
s_mov_b32 s14, 7077888
s_mov_b32 s15, 0x20000
v_lshrrev_b32 v204, 3, v2
v_mul_u32_u24 v196, 4096, v204
v_and_b32 v205, 7, v2
v_and_b32 v204, 2, v204
v_xor_b32 v205, v205, v204
v_lshl_add_u32 v196, v205, 4, v196
v_xor_b32 v197, 64, v196
s_add_u32 s74, s3, 16
s_mul_i32 s74, s74, 131072
s_lshl_b32 s81, s11, 7
s_add_u32 s74, s74, s81
s_mov_b32 s75, 524288
s_mov_b32 s76, 7077888
s_mov_b32 s77, 32768
s_mov_b32 s78, s7
s_waitcnt vmcnt(0)
s_add_u32 s5, s5, 4
s_mov_b64 exec, 1
v_mov_b32 v4, 1
ds_add_u32 v230, v4 offset:0
s_mov_b64 exec, -1
s_mov_b32 s69, 0
Lw37:
ds_read_b32 v4, v230 offset:0
s_add_u32 s69, s69, 1
s_waitcnt lgkmcnt(0)
v_readfirstlane_b32 s68, v4
s_cmp_ge_u32 s68, s5
s_cbranch_scc1 Le38
s_cmp_lt_u32 s69, 2097152
s_cbranch_scc1 Lw37
Le38:
s_cmp_lg_u32 s3, 0
s_cbranch_scc1 L_noflag2
s_mov_b64 exec, 0xf
v_mov_b32 v4, s6
v_lshlrev_b32 v5, 2, v2
buffer_store_dword v4, v5, s[24:27], s50 offen sc1
s_mov_b64 exec, -1
L_noflag2:
s_mov_b64 exec, 1
v_mov_b32 v4, 1
ds_add_u32 v230, v4 offset:20
s_mov_b64 exec, -1
L_pre2:
s_add_u32 m0, s78, 16384
s_nop 0
buffer_load_dwordx4 v196, s[12:15], s74 offen  lds
s_add_u32 m0, s78, 17408
s_add_u32 s81, s74, s77
buffer_load_dwordx4 v197, s[12:15], s81 offen  lds
s_add_u32 m0, s78, 18432
s_add_u32 s81, s81, s77
buffer_load_dwordx4 v196, s[12:15], s81 offen  lds
s_add_u32 m0, s78, 19456
s_add_u32 s81, s81, s77
buffer_load_dwordx4 v197, s[12:15], s81 offen  lds
s_add_u32 s74, s74, s75
s_add_u32 m0, s78, 20480
s_nop 0
buffer_load_dwordx4 v196, s[12:15], s74 offen  lds
s_add_u32 m0, s78, 21504
s_add_u32 s81, s74, s77
buffer_load_dwordx4 v197, s[12:15], s81 offen  lds
s_add_u32 m0, s78, 22528
s_add_u32 s81, s81, s77
buffer_load_dwordx4 v196, s[12:15], s81 offen  lds
s_add_u32 m0, s78, 23552
s_add_u32 s81, s81, s77
buffer_load_dwordx4 v197, s[12:15], s81 offen  lds
s_add_u32 s74, s74, s75
s_add_u32 m0, s78, 24576
s_nop 0
buffer_load_dwordx4 v196, s[12:15], s74 offen  lds
s_add_u32 m0, s78, 25600
s_add_u32 s81, s74, s77
buffer_load_dwordx4 v197, s[12:15], s81 offen  lds
s_add_u32 m0, s78, 26624
s_add_u32 s81, s81, s77
buffer_load_dwordx4 v196, s[12:15], s81 offen  lds
s_add_u32 m0, s78, 27648
s_add_u32 s81, s81, s77
buffer_load_dwordx4 v197, s[12:15], s81 offen  lds
s_add_u32 s74, s74, s75
s_add_u32 m0, s78, 28672
s_nop 0
buffer_load_dwordx4 v196, s[12:15], s74 offen  lds
s_add_u32 m0, s78, 29696
s_add_u32 s81, s74, s77
buffer_load_dwordx4 v197, s[12:15], s81 offen  lds
s_add_u32 m0, s78, 30720
s_add_u32 s81, s81, s77
buffer_load_dwordx4 v196, s[12:15], s81 offen  lds
s_add_u32 m0, s78, 31744
s_add_u32 s81, s81, s77
buffer_load_dwordx4 v197, s[12:15], s81 offen  lds
s_add_u32 s74, s74, s75
L_pre2b:
s_mov_b32 s4, 1
s_add_u32 s78, s7, 16384
v_and_b32 v200, 0xffffbfff, v200
v_and_b32 v201, 0xffffbfff, v201
v_and_b32 v202, 0xffffbfff, v202
v_and_b32 v203, 0xffffbfff, v203
s_mul_i32 s68, s10, 5120
s_add_u32 s68, s68, 5242880
s_add_u32 s16, s66, s68
s_addc_u32 s17, s67, 0
s_and_b32 s17, s17, 0xffff
s_mov_b32 s18, 2211840
s_mov_b32 s19, 0x20000
s_mul_i32 s70, s3, 40960
s_mov_b32 s71, 163840
s_mov_b32 s72, 2211840
s_mov_b32 s73, 2211840
s_mov_b32 s80, 2
s_lshl_b32 s84, s11, 6
s_lshl_b32 s68, s3, 4
s_add_u32 s84, s84, s68
s_add_u32 s28, s66, 7864320
s_addc_u32 s29, s67, 0
s_and_b32 s29, s29, 0xffff
s_mov_b32 s30, 2621440
s_mov_b32 s31, 0x20000
s_add_u32 s32, s66, 10485760
s_addc_u32 s33, s67, 0
s_and_b32 s33, s33, 0xffff
s_mov_b32 s34, 16384
s_mov_b32 s35, 0x20000
v_lshrrev_b32 v226, 4, v2
v_and_b32 v227, 15, v2
s_lshl_b32 s85, s84, 1
v_lshl_add_u32 v206, v226, 3, s85
v_lshlrev_b32 v228, 5, v226
s_lshl_b32 s68, s84, 3
global_load_dwordx2 v[206:207], v206, s[58:59]
buffer_load_dwordx4 v[208:211], v228, s[32:35], s68 offen sc1
buffer_load_dwordx4 v[212:215], v228, s[32:35], s68 offen offset:16 sc1
v_lshlrev_b32 v229, 12, v227
v_lshl_add_u32 v229, v226, 3, v229
s_mov_b32 s32, s62
s_and_b32 s33, s63, 0xffff
s_mov_b32 s34, 2621440
s_mov_b32 s35, 0x20000
v_mul_u32_u24 v238, 704, v226
v_lshl_add_u32 v238, v227, 1, v238
v_add_u32 v238, s7, v238
s_mul_i32 s82, s84, 1280
s_mul_i32 s69, s10, 160
s_add_u32 s82, s82, s69
v_add_u32 v232, 0, v2
v_mul_u32_u24 v233, 205, v232
v_lshrrev_b32 v233, 11, v233
v_mul_u32_u24 v4, 10, v233
v_sub_u32 v4, v232, v4
v_lshlrev_b32 v4, 4, v4
v_mul_u32_u24 v232, 176, v233
v_add3_u32 v232, v232, v4, s7
v_mul_u32_u24 v233, 1280, v233
v_add_u32 v233, v233, v4
v_add_u32 v234, 64, v2
v_mul_u32_u24 v235, 205, v234
v_lshrrev_b32 v235, 11, v235
v_mul_u32_u24 v4, 10, v235
v_sub_u32 v4, v234, v4
v_lshlrev_b32 v4, 4, v4
v_mul_u32_u24 v234, 176, v235
v_add3_u32 v234, v234, v4, s7
v_mul_u32_u24 v235, 1280, v235
v_add_u32 v235, v235, v4
v_add_u32 v236, 128, v2
v_mul_u32_u24 v237, 205, v236
v_lshrrev_b32 v237, 11, v237
v_mul_u32_u24 v4, 10, v237
v_sub_u32 v4, v236, v4
v_lshlrev_b32 v4, 4, v4
v_mul_u32_u24 v236, 176, v237
v_add3_u32 v236, v236, v4, s7
v_mul_u32_u24 v237, 1280, v237
v_add_u32 v237, v237, v4
v_mov_b32 v116, 0
v_mov_b32 v117, 0
v_mov_b32 v118, 0
v_mov_b32 v119, 0
v_mov_b32 v120, 0
v_mov_b32 v121, 0
v_mov_b32 v122, 0
v_mov_b32 v123, 0
v_mov_b32 v124, 0
v_mov_b32 v125, 0
v_mov_b32 v126, 0
v_mov_b32 v127, 0
v_mov_b32 v128, 0
v_mov_b32 v129, 0
v_mov_b32 v130, 0
v_mov_b32 v131, 0
v_mov_b32 v132, 0
v_mov_b32 v133, 0
v_mov_b32 v134, 0
v_mov_b32 v135, 0
v_mov_b32 v136, 0
v_mov_b32 v137, 0
v_mov_b32 v138, 0
v_mov_b32 v139, 0
v_mov_b32 v140, 0
v_mov_b32 v141, 0
v_mov_b32 v142, 0
v_mov_b32 v143, 0
v_mov_b32 v144, 0
v_mov_b32 v145, 0
v_mov_b32 v146, 0
v_mov_b32 v147, 0
v_mov_b32 v148, 0
v_mov_b32 v149, 0
v_mov_b32 v150, 0
v_mov_b32 v151, 0
v_mov_b32 v152, 0
v_mov_b32 v153, 0
v_mov_b32 v154, 0
v_mov_b32 v155, 0
v_mov_b32 v156, 0
v_mov_b32 v157, 0
v_mov_b32 v158, 0
v_mov_b32 v159, 0
v_mov_b32 v160, 0
v_mov_b32 v161, 0
v_mov_b32 v162, 0
v_mov_b32 v163, 0
v_mov_b32 v164, 0
v_mov_b32 v165, 0
v_mov_b32 v166, 0
v_mov_b32 v167, 0
v_mov_b32 v168, 0
v_mov_b32 v169, 0
v_mov_b32 v170, 0
v_mov_b32 v171, 0
v_mov_b32 v172, 0
v_mov_b32 v173, 0
v_mov_b32 v174, 0
v_mov_b32 v175, 0
v_mov_b32 v176, 0
v_mov_b32 v177, 0
v_mov_b32 v178, 0
v_mov_b32 v179, 0
v_mov_b32 v180, 0
v_mov_b32 v181, 0
v_mov_b32 v182, 0
v_mov_b32 v183, 0
v_mov_b32 v184, 0
v_mov_b32 v185, 0
v_mov_b32 v186, 0
v_mov_b32 v187, 0
v_mov_b32 v188, 0
v_mov_b32 v189, 0
v_mov_b32 v190, 0
v_mov_b32 v191, 0
v_mov_b32 v192, 0
v_mov_b32 v193, 0
v_mov_b32 v194, 0
v_mov_b32 v195, 0
s_cmp_lg_u32 s3, 0
s_cbranch_scc1 L_w2
v_lshlrev_b32 v36, 7, v2
s_lshl_b32 s50, s10, 12
s_add_u32 s50, s50, 65536
s_mov_b64 exec, 0x7ffffff
s_mov_b32 s69, 0
Lp39:
buffer_load_dwordx4 v[40:43], v36, s[24:27], s50 offen sc1
s_add_u32 s69, s69, 1
s_waitcnt vmcnt(0)
v_xor_b32 v40, s6, v40
v_xor_b32 v41, s6, v41
v_xor_b32 v42, s6, v42
v_xor_b32 v43, s6, v43
v_or3_b32 v40, v40, v41, v42
v_or_b32 v40, v40, v43
v_cmp_ne_u32 vcc, 0, v40
s_and_b64 exec, exec, vcc
s_cbranch_execz Lq40
s_sleep 1
s_cmp_lt_u32 s69, 131072
s_cbranch_scc1 Lp39
Lq40:
s_mov_b64 exec, -1
s_mov_b64 exec, 1
v_mov_b32 v36, 1
ds_add_u32 v230, v36 offset:8
s_mov_b64 exec, -1
L_w2:
s_mov_b32 s69, 0
Lw41:
ds_read_b32 v36, v230 offset:8
s_add_u32 s69, s69, 1
s_waitcnt lgkmcnt(0)
v_readfirstlane_b32 s68, v36
s_cmp_ge_u32 s68, 2
s_cbranch_scc1 Le42
s_sleep 1
s_cmp_lt_u32 s69, 2097152
s_cbranch_scc1 Lw41
Le42:
s_mov_b32 s76, 0
s_branch L_gemm
L_final:
v_mul_f32 v36, v36, v209
v_mul_f32 v37, v37, v211
v_mul_f32 v38, v38, v213
v_mul_f32 v39, v39, v215
v_mul_f32 v40, v40, v209
v_mul_f32 v41, v41, v211
v_mul_f32 v42, v42, v213
v_mul_f32 v43, v43, v215
v_mul_f32 v44, v44, v209
v_mul_f32 v45, v45, v211
v_mul_f32 v46, v46, v213
v_mul_f32 v47, v47, v215
v_mul_f32 v48, v48, v209
v_mul_f32 v49, v49, v211
v_mul_f32 v50, v50, v213
v_mul_f32 v51, v51, v215
v_mul_f32 v52, v52, v209
v_mul_f32 v53, v53, v211
v_mul_f32 v54, v54, v213
v_mul_f32 v55, v55, v215
v_cvt_pk_bf16_f32 v36, v36, v37
v_cvt_pk_bf16_f32 v38, v38, v39
v_cvt_pk_bf16_f32 v40, v40, v41
v_cvt_pk_bf16_f32 v42, v42, v43
v_cvt_pk_bf16_f32 v44, v44, v45
v_cvt_pk_bf16_f32 v46, v46, v47
v_cvt_pk_bf16_f32 v48, v48, v49
v_cvt_pk_bf16_f32 v50, v50, v51
v_cvt_pk_bf16_f32 v52, v52, v53
v_cvt_pk_bf16_f32 v54, v54, v55
v_and_b32 v37, 0xffff0000, v36
v_lshlrev_b32 v36, 16, v36
v_and_b32 v39, 0xffff0000, v38
v_lshlrev_b32 v38, 16, v38
v_and_b32 v41, 0xffff0000, v40
v_lshlrev_b32 v40, 16, v40
v_and_b32 v43, 0xffff0000, v42
v_lshlrev_b32 v42, 16, v42
v_and_b32 v45, 0xffff0000, v44
v_lshlrev_b32 v44, 16, v44
v_and_b32 v47, 0xffff0000, v46
v_lshlrev_b32 v46, 16, v46
v_and_b32 v49, 0xffff0000, v48
v_lshlrev_b32 v48, 16, v48
v_and_b32 v51, 0xffff0000, v50
v_lshlrev_b32 v50, 16, v50
v_and_b32 v53, 0xffff0000, v52
v_lshlrev_b32 v52, 16, v52
v_and_b32 v55, 0xffff0000, v54
v_lshlrev_b32 v54, 16, v54
v_pk_add_f32 v[36:37], v[36:37], v[12:13]
v_pk_add_f32 v[38:39], v[38:39], v[14:15]
v_pk_add_f32 v[40:41], v[40:41], v[16:17]
v_pk_add_f32 v[42:43], v[42:43], v[18:19]
v_pk_add_f32 v[44:45], v[44:45], v[20:21]
v_pk_add_f32 v[46:47], v[46:47], v[22:23]
v_pk_add_f32 v[48:49], v[48:49], v[24:25]
v_pk_add_f32 v[50:51], v[50:51], v[26:27]
v_pk_add_f32 v[52:53], v[52:53], v[28:29]
v_pk_add_f32 v[54:55], v[54:55], v[30:31]
v_cvt_pk_bf16_f32 v36, v36, v37
v_cvt_pk_bf16_f32 v37, v38, v39
ds_write_b16 v238, v36 offset:0
ds_write_b16_d16_hi v238, v36 offset:176
ds_write_b16 v238, v37 offset:352
ds_write_b16_d16_hi v238, v37 offset:528
v_cvt_pk_bf16_f32 v40, v40, v41
v_cvt_pk_bf16_f32 v41, v42, v43
ds_write_b16 v238, v40 offset:32
ds_write_b16_d16_hi v238, v40 offset:208
ds_write_b16 v238, v41 offset:384
ds_write_b16_d16_hi v238, v41 offset:560
v_cvt_pk_bf16_f32 v44, v44, v45
v_cvt_pk_bf16_f32 v45, v46, v47
ds_write_b16 v238, v44 offset:64
ds_write_b16_d16_hi v238, v44 offset:240
ds_write_b16 v238, v45 offset:416
ds_write_b16_d16_hi v238, v45 offset:592
v_cvt_pk_bf16_f32 v48, v48, v49
v_cvt_pk_bf16_f32 v49, v50, v51
ds_write_b16 v238, v48 offset:96
ds_write_b16_d16_hi v238, v48 offset:272
ds_write_b16 v238, v49 offset:448
ds_write_b16_d16_hi v238, v49 offset:624
v_cvt_pk_bf16_f32 v52, v52, v53
v_cvt_pk_bf16_f32 v53, v54, v55
ds_write_b16 v238, v52 offset:128
ds_write_b16_d16_hi v238, v52 offset:304
ds_write_b16 v238, v53 offset:480
ds_write_b16_d16_hi v238, v53 offset:656
ds_read_b128 v[96:99], v232
ds_read_b128 v[100:103], v234
ds_read_b128 v[104:107], v236
s_waitcnt lgkmcnt(2)
buffer_store_dwordx4 v[96:99], v233, s[32:35], s82 offen
s_waitcnt lgkmcnt(1)
buffer_store_dwordx4 v[100:103], v235, s[32:35], s82 offen
s_waitcnt lgkmcnt(0)
s_mov_b32 exec_hi, 0
buffer_store_dwordx4 v[104:107], v237, s[32:35], s82 offen
s_endpgm
L_freecu:
s_mov_b64 exec, 1
v_mov_b32 v36, 1
ds_add_u32 v230, v36 offset:20
s_mov_b64 exec, -1
s_and_b32 s10, s9, 7
s_lshl_b32 s11, s8, 2
s_lshr_b32 s68, s9, 3
s_add_u32 s11, s11, s68
s_mov_b32 s12, s56
s_and_b32 s13, s57, 0xffff
s_mov_b32 s14, 7077888
s_mov_b32 s15, 0x20000
v_lshrrev_b32 v204, 3, v2
v_mul_u32_u24 v196, 4096, v204
v_and_b32 v205, 7, v2
v_and_b32 v204, 2, v204
v_xor_b32 v205, v205, v204
v_lshl_add_u32 v196, v205, 4, v196
v_xor_b32 v197, 64, v196
s_add_u32 s74, s3, 16
s_mul_i32 s74, s74, 131072
s_lshl_b32 s81, s11, 7
s_add_u32 s74, s74, s81
s_mov_b32 s75, 524288
s_mov_b32 s76, 7077888
s_mov_b32 s77, 32768
s_mov_b32 s78, s7
s_lshl_b32 s68, s8, 3
s_add_u32 s68, s68, s9
s_sub_u32 s69, 3, s3
s_mul_i32 s69, s69, 40
s_add_u32 s68, s68, s69
s_add_u32 s68, s68, 464
s_cmp_ge_u32 s68, 640
s_cbranch_scc1 L_waitf1
s_mov_b32 s22, s68
s_add_u32 s23, s7, 16384
s_setprio 0
s_mov_b32 s0, 1
s_branch L_chan
L_chan_ret:
s_setprio 1
s_mov_b64 exec, 1
v_mov_b32 v36, 1
ds_add_u32 v230, v36 offset:20
s_mov_b64 exec, -1
s_branch L_pre2
L_lwave:
s_waitcnt lgkmcnt(0)
s_add_u32 s24, s66, 12582912
s_addc_u32 s25, s67, 0
s_and_b32 s25, s25, 0xffff
s_mov_b32 s26, 262144
s_mov_b32 s27, 0x20000
s_mov_b32 s12, s52
s_and_b32 s13, s53, 0xffff
s_mov_b32 s14, 7077888
s_mov_b32 s15, 0x20000
v_lshrrev_b32 v204, 3, v2
v_mul_u32_u24 v196, 3456, v204
v_and_b32 v205, 7, v2
v_and_b32 v204, 2, v204
v_xor_b32 v205, v205, v204
v_lshl_add_u32 v196, v205, 4, v196
v_xor_b32 v197, 64, v196
s_lshl_b32 s74, s11, 7
s_mov_b32 s75, 442368
s_mov_b32 s76, 7077888
s_mov_b32 s77, 27648
s_barrier
s_cmp_lg_u32 s4, 0
s_cbranch_scc1 L_lfree
s_and_b32 s68, s9, 7
s_mul_i32 s68, s68, 442368
s_add_u32 s68, s68, s74
v_mul_u32_u24 v36, 3456, v2
buffer_load_dword v231, v36, s[12:15], s68 offen
s_add_u32 s68, s68, 221184
buffer_load_dword v231, v36, s[12:15], s68 offen
s_add_u32 s68, s68, 221184
s_mov_b64 exec, -1
s_mov_b32 s69, 0
Lw43:
ds_read_b32 v36, v230 offset:16
s_add_u32 s69, s69, 1
s_waitcnt lgkmcnt(0)
v_readfirstlane_b32 s68, v36
s_cmp_ge_u32 s68, 5
s_cbranch_scc1 Le44
s_cmp_lt_u32 s69, 2097152
s_cbranch_scc1 Lw43
Le44:
s_add_u32 s74, s74, 3538944
s_and_b32 s68, s9, 7
s_mul_i32 s68, s68, 442368
s_add_u32 s68, s68, s74
v_mul_u32_u24 v36, 3456, v2
buffer_load_dword v231, v36, s[12:15], s68 offen
s_add_u32 s68, s68, 221184
buffer_load_dword v231, v36, s[12:15], s68 offen
s_add_u32 s68, s68, 221184
s_mov_b64 exec, -1
s_sub_u32 s74, s74, 3538944
s_mov_b32 s78, 0
s_mov_b32 s79, 0
s_mov_b32 s71, s74
Ll45:
s_mul_i32 s70, s79, s75
s_add_u32 s74, s71, s70
s_add_u32 m0, s78, 0
s_nop 0
buffer_load_dwordx4 v196, s[12:15], s74 offen  lds
s_add_u32 m0, s78, 1024
s_add_u32 s81, s74, s77
buffer_load_dwordx4 v197, s[12:15], s81 offen  lds
s_add_u32 m0, s78, 2048
s_add_u32 s81, s81, s77
buffer_load_dwordx4 v196, s[12:15], s81 offen  lds
s_add_u32 m0, s78, 3072
s_add_u32 s81, s81, s77
buffer_load_dwordx4 v197, s[12:15], s81 offen  lds
s_add_u32 m0, s78, 32768
s_add_u32 s81, s81, s77
buffer_load_dwordx4 v196, s[12:15], s81 offen  lds
s_add_u32 m0, s78, 33792
s_add_u32 s81, s81, s77
buffer_load_dwordx4 v197, s[12:15], s81 offen  lds
s_add_u32 m0, s78, 34816
s_add_u32 s81, s81, s77
buffer_load_dwordx4 v196, s[12:15], s81 offen  lds
s_add_u32 m0, s78, 35840
s_add_u32 s81, s81, s77
buffer_load_dwordx4 v197, s[12:15], s81 offen  lds
s_add_u32 m0, s78, 65536
s_add_u32 s81, s81, s77
buffer_load_dwordx4 v196, s[12:15], s81 offen  lds
s_add_u32 m0, s78, 66560
s_add_u32 s81, s81, s77
buffer_load_dwordx4 v197, s[12:15], s81 offen  lds
s_add_u32 m0, s78, 67584
s_add_u32 s81, s81, s77
buffer_load_dwordx4 v196, s[12:15], s81 offen  lds
s_add_u32 m0, s78, 68608
s_add_u32 s81, s81, s77
buffer_load_dwordx4 v197, s[12:15], s81 offen  lds
s_add_u32 m0, s78, 98304
s_add_u32 s81, s81, s77
buffer_load_dwordx4 v196, s[12:15], s81 offen  lds
s_add_u32 m0, s78, 99328
s_add_u32 s81, s81, s77
buffer_load_dwordx4 v197, s[12:15], s81 offen  lds
s_add_u32 m0, s78, 100352
s_add_u32 s81, s81, s77
buffer_load_dwordx4 v196, s[12:15], s81 offen  lds
s_add_u32 m0, s78, 101376
s_add_u32 s81, s81, s77
buffer_load_dwordx4 v197, s[12:15], s81 offen  lds
s_add_u32 s78, s78, 4096
s_add_u32 s79, s79, 1
s_cmp_lt_u32 s79, 4
s_cbranch_scc1 Ll45
s_mul_i32 s70, s75, 4
s_add_u32 s74, s71, s70
s_waitcnt vmcnt(0)
L_lfree:
L_l2:
s_mov_b64 exec, 1
v_mov_b32 v36, 1
ds_add_u32 v230, v36 offset:24
s_mov_b64 exec, -1
s_mov_b64 exec, 1
v_mov_b32 v36, 1
ds_add_u32 v230, v36 offset:36
s_mov_b64 exec, -1
s_and_b32 s10, s9, 7
s_lshl_b32 s11, s8, 2
s_lshr_b32 s68, s9, 3
s_add_u32 s11, s11, s68
s_mov_b32 s12, s56
s_and_b32 s13, s57, 0xffff
s_mov_b32 s14, 7077888
s_mov_b32 s15, 0x20000
v_lshrrev_b32 v204, 3, v2
v_mul_u32_u24 v196, 4096, v204
v_and_b32 v205, 7, v2
v_and_b32 v204, 2, v204
v_xor_b32 v205, v205, v204
v_lshl_add_u32 v196, v205, 4, v196
v_xor_b32 v197, 64, v196
s_lshl_b32 s74, s11, 7
s_mov_b32 s75, 524288
s_mov_b32 s76, 7077888
s_mov_b32 s77, 32768
s_mov_b32 s69, 0
Lw46:
ds_read_b32 v36, v230 offset:20
s_add_u32 s69, s69, 1
s_waitcnt lgkmcnt(0)
v_readfirstlane_b32 s68, v36
s_cmp_ge_u32 s68, 4
s_cbranch_scc1 Le47
s_sleep 1
s_cmp_lt_u32 s69, 2097152
s_cbranch_scc1 Lw46
Le47:
s_and_b32 s68, s9, 7
s_mul_i32 s68, s68, 884736
s_add_u32 s68, s68, s74
v_mul_u32_u24 v36, 4096, v2
buffer_load_dword v231, v36, s[12:15], s68 offen
s_add_u32 s68, s68, 262144
buffer_load_dword v231, v36, s[12:15], s68 offen
s_add_u32 s68, s68, 262144
buffer_load_dword v231, v36, s[12:15], s68 offen
s_add_u32 s68, s68, 262144
s_mov_b64 exec, 0xffffff
buffer_load_dword v231, v36, s[12:15], s68 offen
s_add_u32 s68, s68, 262144
s_mov_b64 exec, -1
s_mov_b32 s78, 0
s_mov_b32 s79, 0
s_mov_b32 s71, s74
Ll48:
s_mul_i32 s70, s79, s75
s_add_u32 s74, s71, s70
s_add_u32 m0, s78, 0
s_nop 0
buffer_load_dwordx4 v196, s[12:15], s74 offen  lds
s_add_u32 m0, s78, 1024
s_add_u32 s81, s74, s77
buffer_load_dwordx4 v197, s[12:15], s81 offen  lds
s_add_u32 m0, s78, 2048
s_add_u32 s81, s81, s77
buffer_load_dwordx4 v196, s[12:15], s81 offen  lds
s_add_u32 m0, s78, 3072
s_add_u32 s81, s81, s77
buffer_load_dwordx4 v197, s[12:15], s81 offen  lds
s_add_u32 m0, s78, 32768
s_add_u32 s81, s81, s77
buffer_load_dwordx4 v196, s[12:15], s81 offen  lds
s_add_u32 m0, s78, 33792
s_add_u32 s81, s81, s77
buffer_load_dwordx4 v197, s[12:15], s81 offen  lds
s_add_u32 m0, s78, 34816
s_add_u32 s81, s81, s77
buffer_load_dwordx4 v196, s[12:15], s81 offen  lds
s_add_u32 m0, s78, 35840
s_add_u32 s81, s81, s77
buffer_load_dwordx4 v197, s[12:15], s81 offen  lds
s_add_u32 m0, s78, 65536
s_add_u32 s81, s81, s77
buffer_load_dwordx4 v196, s[12:15], s81 offen  lds
s_add_u32 m0, s78, 66560
s_add_u32 s81, s81, s77
buffer_load_dwordx4 v197, s[12:15], s81 offen  lds
s_add_u32 m0, s78, 67584
s_add_u32 s81, s81, s77
buffer_load_dwordx4 v196, s[12:15], s81 offen  lds
s_add_u32 m0, s78, 68608
s_add_u32 s81, s81, s77
buffer_load_dwordx4 v197, s[12:15], s81 offen  lds
s_add_u32 m0, s78, 98304
s_add_u32 s81, s81, s77
buffer_load_dwordx4 v196, s[12:15], s81 offen  lds
s_add_u32 m0, s78, 99328
s_add_u32 s81, s81, s77
buffer_load_dwordx4 v197, s[12:15], s81 offen  lds
s_add_u32 m0, s78, 100352
s_add_u32 s81, s81, s77
buffer_load_dwordx4 v196, s[12:15], s81 offen  lds
s_add_u32 m0, s78, 101376
s_add_u32 s81, s81, s77
buffer_load_dwordx4 v197, s[12:15], s81 offen  lds
s_add_u32 s78, s78, 4096
s_add_u32 s79, s79, 1
s_cmp_lt_u32 s79, 4
s_cbranch_scc1 Ll48
s_mul_i32 s70, s75, 4
s_add_u32 s74, s71, s70
s_waitcnt vmcnt(0)
s_mov_b64 exec, 1
v_mov_b32 v36, 1
ds_add_u32 v230, v36 offset:8
s_mov_b64 exec, -1
s_mov_b64 exec, 1
v_mov_b32 v36, 1
ds_add_u32 v230, v36 offset:36
s_mov_b64 exec, -1
v_mov_b32 v4, v196
v_mov_b32 v5, v197
v_lshlrev_b32 v6, 4, v2
v_add_u32 v7, 0x10000, v6
s_lshl_b32 s70, s11, 7
s_add_u32 s81, s70, 4718592
buffer_load_dwordx4 v[36:39], v4, s[12:15], s81 offen
s_add_u32 s81, s70, 4751360
buffer_load_dwordx4 v[40:43], v5, s[12:15], s81 offen
s_add_u32 s81, s70, 4784128
buffer_load_dwordx4 v[44:47], v4, s[12:15], s81 offen
s_add_u32 s81, s70, 4816896
buffer_load_dwordx4 v[48:51], v5, s[12:15], s81 offen
s_add_u32 s81, s70, 4849664
buffer_load_dwordx4 v[52:55], v4, s[12:15], s81 offen
s_add_u32 s81, s70, 4882432
buffer_load_dwordx4 v[56:59], v5, s[12:15], s81 offen
s_add_u32 s81, s70, 4915200
buffer_load_dwordx4 v[60:63], v4, s[12:15], s81 offen
s_add_u32 s81, s70, 4947968
buffer_load_dwordx4 v[64:67], v5, s[12:15], s81 offen
s_add_u32 s81, s70, 4980736
buffer_load_dwordx4 v[68:71], v4, s[12:15], s81 offen
s_add_u32 s81, s70, 5013504
buffer_load_dwordx4 v[72:75], v5, s[12:15], s81 offen
s_add_u32 s81, s70, 5046272
buffer_load_dwordx4 v[76:79], v4, s[12:15], s81 offen
s_add_u32 s81, s70, 5079040
buffer_load_dwordx4 v[80:83], v5, s[12:15], s81 offen
s_add_u32 s81, s70, 5111808
buffer_load_dwordx4 v[84:87], v4, s[12:15], s81 offen
s_add_u32 s81, s70, 5144576
buffer_load_dwordx4 v[88:91], v5, s[12:15], s81 offen
s_add_u32 s81, s70, 5177344
buffer_load_dwordx4 v[92:95], v4, s[12:15], s81 offen
s_add_u32 s81, s70, 5210112
buffer_load_dwordx4 v[96:99], v5, s[12:15], s81 offen
s_add_u32 s81, s70, 5767168
buffer_load_dwordx4 v[100:103], v4, s[12:15], s81 offen
s_add_u32 s81, s70, 5799936
buffer_load_dwordx4 v[104:107], v5, s[12:15], s81 offen
s_add_u32 s81, s70, 5832704
buffer_load_dwordx4 v[108:111], v4, s[12:15], s81 offen
s_add_u32 s81, s70, 5865472
buffer_load_dwordx4 v[112:115], v5, s[12:15], s81 offen
s_add_u32 s81, s70, 5898240
buffer_load_dwordx4 v[116:119], v4, s[12:15], s81 offen
s_add_u32 s81, s70, 5931008
buffer_load_dwordx4 v[120:123], v5, s[12:15], s81 offen
s_add_u32 s81, s70, 5963776
buffer_load_dwordx4 v[124:127], v4, s[12:15], s81 offen
s_add_u32 s81, s70, 5996544
buffer_load_dwordx4 v[128:131], v5, s[12:15], s81 offen
s_add_u32 s81, s70, 6029312
buffer_load_dwordx4 v[132:135], v4, s[12:15], s81 offen
s_add_u32 s81, s70, 6062080
buffer_load_dwordx4 v[136:139], v5, s[12:15], s81 offen
s_add_u32 s81, s70, 6094848
buffer_load_dwordx4 v[140:143], v4, s[12:15], s81 offen
s_add_u32 s81, s70, 6127616
buffer_load_dwordx4 v[144:147], v5, s[12:15], s81 offen
s_add_u32 s81, s70, 6160384
buffer_load_dwordx4 v[148:151], v4, s[12:15], s81 offen
s_add_u32 s81, s70, 6193152
buffer_load_dwordx4 v[152:155], v5, s[12:15], s81 offen
s_add_u32 s81, s70, 6225920
buffer_load_dwordx4 v[156:159], v4, s[12:15], s81 offen
s_add_u32 s81, s70, 6258688
buffer_load_dwordx4 v[160:163], v5, s[12:15], s81 offen
s_add_u32 s81, s70, 6291456
buffer_load_dwordx4 v[164:167], v4, s[12:15], s81 offen
s_add_u32 s81, s70, 6324224
buffer_load_dwordx4 v[168:171], v5, s[12:15], s81 offen
s_add_u32 s81, s70, 6356992
buffer_load_dwordx4 v[172:175], v4, s[12:15], s81 offen
s_add_u32 s81, s70, 6389760
buffer_load_dwordx4 v[176:179], v5, s[12:15], s81 offen
s_add_u32 s81, s70, 6422528
buffer_load_dwordx4 v[180:183], v4, s[12:15], s81 offen
s_add_u32 s81, s70, 6455296
buffer_load_dwordx4 v[184:187], v5, s[12:15], s81 offen
s_add_u32 s81, s70, 6488064
buffer_load_dwordx4 v[188:191], v4, s[12:15], s81 offen
s_add_u32 s81, s70, 6520832
buffer_load_dwordx4 v[192:195], v5, s[12:15], s81 offen
s_add_u32 s81, s70, 6553600
buffer_load_dwordx4 v[196:199], v4, s[12:15], s81 offen
s_add_u32 s81, s70, 6586368
buffer_load_dwordx4 v[200:203], v5, s[12:15], s81 offen
s_add_u32 s81, s70, 6619136
buffer_load_dwordx4 v[204:207], v4, s[12:15], s81 offen
s_add_u32 s81, s70, 6651904
buffer_load_dwordx4 v[208:211], v5, s[12:15], s81 offen
s_add_u32 s81, s70, 6684672
buffer_load_dwordx4 v[212:215], v4, s[12:15], s81 offen
s_add_u32 s81, s70, 6717440
buffer_load_dwordx4 v[216:219], v5, s[12:15], s81 offen
s_add_u32 s81, s70, 6750208
buffer_load_dwordx4 v[220:223], v4, s[12:15], s81 offen
s_add_u32 s81, s70, 6782976
buffer_load_dwordx4 v[224:227], v5, s[12:15], s81 offen
s_mov_b32 s69, 0
Lw49:
ds_read_b32 v8, v230 offset:20
s_add_u32 s69, s69, 1
s_waitcnt lgkmcnt(0)
v_readfirstlane_b32 s68, v8
s_cmp_ge_u32 s68, 12
s_cbranch_scc1 Le50
s_cmp_lt_u32 s69, 2097152
s_cbranch_scc1 Lw49
Le50:
s_waitcnt vmcnt(0)
ds_write_b128 v6, v[36:39] offset:4096
ds_write_b128 v6, v[40:43] offset:5120
ds_write_b128 v6, v[44:47] offset:6144
ds_write_b128 v6, v[48:51] offset:7168
ds_write_b128 v6, v[52:55] offset:36864
ds_write_b128 v6, v[56:59] offset:37888
ds_write_b128 v6, v[60:63] offset:38912
ds_write_b128 v6, v[64:67] offset:39936
ds_write_b128 v7, v[68:71] offset:4096
ds_write_b128 v7, v[72:75] offset:5120
ds_write_b128 v7, v[76:79] offset:6144
ds_write_b128 v7, v[80:83] offset:7168
ds_write_b128 v7, v[84:87] offset:36864
ds_write_b128 v7, v[88:91] offset:37888
ds_write_b128 v7, v[92:95] offset:38912
ds_write_b128 v7, v[96:99] offset:39936
ds_write_b128 v6, v[100:103] offset:12288
ds_write_b128 v6, v[104:107] offset:13312
ds_write_b128 v6, v[108:111] offset:14336
ds_write_b128 v6, v[112:115] offset:15360
ds_write_b128 v6, v[116:119] offset:45056
ds_write_b128 v6, v[120:123] offset:46080
ds_write_b128 v6, v[124:127] offset:47104
ds_write_b128 v6, v[128:131] offset:48128
ds_write_b128 v7, v[132:135] offset:12288
ds_write_b128 v7, v[136:139] offset:13312
ds_write_b128 v7, v[140:143] offset:14336
ds_write_b128 v7, v[144:147] offset:15360
ds_write_b128 v7, v[148:151] offset:45056
ds_write_b128 v7, v[152:155] offset:46080
ds_write_b128 v7, v[156:159] offset:47104
ds_write_b128 v7, v[160:163] offset:48128
s_mov_b64 exec, 1
v_mov_b32 v8, 1
ds_add_u32 v230, v8 offset:44
s_mov_b64 exec, -1
ds_read_b32 v36, v230 offset:12
v_lshlrev_b32 v37, 7, v2
v_and_b32 v38, 15, v2
v_lshlrev_b32 v38, 7, v38
s_mul_i32 s51, s10, 2560
s_add_u32 s51, s51, 131072
s_waitcnt lgkmcnt(0)
v_readfirstlane_b32 s6, v36
s_mov_b64 exec, 0xfffff
s_mov_b32 s69, 0
Lp51:
buffer_load_dwordx4 v[40:43], v37, s[24:27], s51 offen sc1
s_add_u32 s69, s69, 1
s_waitcnt vmcnt(0)
v_xor_b32 v40, s6, v40
v_xor_b32 v41, s6, v41
v_xor_b32 v42, s6, v42
v_xor_b32 v43, s6, v43
v_or3_b32 v40, v40, v41, v42
v_or_b32 v40, v40, v43
v_cmp_ne_u32 vcc, 0, v40
s_and_b64 exec, exec, vcc
s_cbranch_execz Lq52
s_sleep 12
s_cmp_lt_u32 s69, 131072
s_cbranch_scc1 Lp51
Lq52:
s_mov_b64 exec, -1
s_add_u32 s28, s66, 7864320
s_addc_u32 s29, s67, 0
s_and_b32 s29, s29, 0xffff
s_mov_b32 s30, 2621440
s_mov_b32 s31, 0x20000
s_mul_i32 s68, s10, 327680
s_lshl_b32 s69, s11, 7
s_add_u32 s68, s68, s69
v_lshlrev_b32 v36, 12, v2
v_lshlrev_b32 v37, 5, v38
buffer_load_dword v231, v36, s[28:31], s68 offen sc1
s_add_u32 s68, s68, 262144
buffer_load_dword v231, v37, s[28:31], s68 offen sc1
s_mov_b64 exec, 1
v_mov_b32 v36, 2
ds_add_u32 v230, v36 offset:28
s_mov_b64 exec, -1
s_mov_b32 s69, 0
Lw53:
ds_read_b32 v8, v230 offset:20
s_add_u32 s69, s69, 1
s_waitcnt lgkmcnt(0)
v_readfirstlane_b32 s68, v8
s_cmp_ge_u32 s68, 16
s_cbranch_scc1 Le54
s_cmp_lt_u32 s69, 2097152
s_cbranch_scc1 Lw53
Le54:
ds_write_b128 v6, v[164:167] offset:16384
ds_write_b128 v6, v[168:171] offset:17408
ds_write_b128 v6, v[172:175] offset:18432
ds_write_b128 v6, v[176:179] offset:19456
ds_write_b128 v6, v[180:183] offset:49152
ds_write_b128 v6, v[184:187] offset:50176
ds_write_b128 v6, v[188:191] offset:51200
ds_write_b128 v6, v[192:195] offset:52224
ds_write_b128 v7, v[196:199] offset:16384
ds_write_b128 v7, v[200:203] offset:17408
ds_write_b128 v7, v[204:207] offset:18432
ds_write_b128 v7, v[208:211] offset:19456
ds_write_b128 v7, v[212:215] offset:49152
ds_write_b128 v7, v[216:219] offset:50176
ds_write_b128 v7, v[220:223] offset:51200
ds_write_b128 v7, v[224:227] offset:52224
s_mov_b64 exec, 1
v_mov_b32 v8, 1
ds_add_u32 v230, v8 offset:48
s_mov_b64 exec, -1
s_endpgm
L_hwave:
v_lshrrev_b32 v4, 3, v2
v_mul_u32_u24 v4, 1280, v4
v_and_b32 v5, 7, v2
v_lshl_add_u32 v4, v5, 4, v4
v_lshrrev_b32 v5, 1, v2
v_mul_u32_u24 v5, 1280, v5
v_and_b32 v6, 1, v2
v_lshl_add_u32 v5, v6, 4, v5
v_add_u32 v5, 128, v5
s_waitcnt lgkmcnt(0)
s_mov_b32 s28, s36
s_and_b32 s29, s37, 0xffff
s_mov_b32 s30, 2621440
s_mov_b32 s31, 0x20000
s_and_b32 s10, s9, 7
s_lshl_b32 s84, s8, 2
s_lshr_b32 s68, s9, 3
s_add_u32 s84, s84, s68
s_mul_i32 s70, s84, 81920
s_mul_i32 s68, s10, 160
s_add_u32 s70, s70, s68
s_mov_b32 m0, 146576
s_add_u32 s71, s70, 0
buffer_load_dwordx4 v4, s[28:31], s71 offen  lds
s_mov_b32 m0, 147600
s_add_u32 s71, s70, 10240
buffer_load_dwordx4 v4, s[28:31], s71 offen  lds
s_mov_b32 m0, 148624
s_add_u32 s71, s70, 20480
buffer_load_dwordx4 v4, s[28:31], s71 offen  lds
s_mov_b32 m0, 149648
s_add_u32 s71, s70, 30720
buffer_load_dwordx4 v4, s[28:31], s71 offen  lds
s_mov_b32 m0, 150672
s_add_u32 s71, s70, 40960
buffer_load_dwordx4 v4, s[28:31], s71 offen  lds
s_mov_b32 m0, 151696
s_add_u32 s71, s70, 51200
buffer_load_dwordx4 v4, s[28:31], s71 offen  lds
s_mov_b32 m0, 152720
s_add_u32 s71, s70, 61440
buffer_load_dwordx4 v4, s[28:31], s71 offen  lds
s_mov_b32 m0, 153744
s_add_u32 s71, s70, 71680
buffer_load_dwordx4 v4, s[28:31], s71 offen  lds
s_mov_b32 m0, 154768
s_add_u32 s71, s70, 0
buffer_load_dwordx4 v5, s[28:31], s71 offen  lds
s_mov_b32 m0, 155792
s_add_u32 s71, s70, 40960
buffer_load_dwordx4 v5, s[28:31], s71 offen  lds
s_barrier
v_lshrrev_b32 v4, 4, v2
v_bfe_u32 v5, v2, 2, 2
v_lshl_add_u32 v5, v4, 3, v5
v_and_b32 v6, 3, v2
v_lshlrev_b32 v6, 3, v6
v_lshl_add_u32 v7, v5, 5, v6
v_add_u32 v7, 154768, v7
v_lshl_add_u32 v5, v5, 7, v6
v_add_u32 v5, 146576, v5
v_and_b32 v6, 15, v2
v_lshlrev_b32 v6, 12, v6
v_lshl_add_u32 v6, v4, 4, v6
s_add_u32 s28, s66, 2621440
s_addc_u32 s29, s67, 0
s_and_b32 s29, s29, 0xffff
s_mov_b32 s30, 2621440
s_mov_b32 s31, 0x20000
s_mul_i32 s70, s10, 327680
s_lshl_b32 s68, s84, 7
s_add_u32 s70, s70, s68
s_waitcnt vmcnt(0)
ds_read_b64_tr_b16 v[40:41], v5 offset:0
ds_read_b64_tr_b16 v[42:43], v5 offset:512
ds_read_b64_tr_b16 v[44:45], v5 offset:4096
ds_read_b64_tr_b16 v[46:47], v5 offset:4608
ds_read_b64_tr_b16 v[48:49], v5 offset:32
ds_read_b64_tr_b16 v[50:51], v5 offset:544
ds_read_b64_tr_b16 v[52:53], v5 offset:4128
ds_read_b64_tr_b16 v[54:55], v5 offset:4640
ds_read_b64_tr_b16 v[56:57], v5 offset:64
ds_read_b64_tr_b16 v[58:59], v5 offset:576
ds_read_b64_tr_b16 v[60:61], v5 offset:4160
ds_read_b64_tr_b16 v[62:63], v5 offset:4672
ds_read_b64_tr_b16 v[64:65], v5 offset:96
ds_read_b64_tr_b16 v[66:67], v5 offset:608
ds_read_b64_tr_b16 v[68:69], v5 offset:4192
ds_read_b64_tr_b16 v[70:71], v5 offset:4704
ds_read_b64_tr_b16 v[72:73], v7 offset:0
ds_read_b64_tr_b16 v[74:75], v7 offset:128
ds_read_b64_tr_b16 v[76:77], v7 offset:1024
ds_read_b64_tr_b16 v[78:79], v7 offset:1152
s_waitcnt lgkmcnt(15)
buffer_store_dwordx4 v[40:43], v6, s[28:31], s70 offen offset:0 sc1
s_waitcnt lgkmcnt(15)
buffer_store_dwordx4 v[44:47], v6, s[28:31], s70 offen offset:64 sc1
s_add_u32 s70, s70, 65536
s_waitcnt lgkmcnt(14)
buffer_store_dwordx4 v[48:51], v6, s[28:31], s70 offen offset:0 sc1
s_waitcnt lgkmcnt(12)
buffer_store_dwordx4 v[52:55], v6, s[28:31], s70 offen offset:64 sc1
s_add_u32 s70, s70, 65536
s_waitcnt lgkmcnt(10)
buffer_store_dwordx4 v[56:59], v6, s[28:31], s70 offen offset:0 sc1
s_waitcnt lgkmcnt(8)
buffer_store_dwordx4 v[60:63], v6, s[28:31], s70 offen offset:64 sc1
s_add_u32 s70, s70, 65536
s_waitcnt lgkmcnt(6)
buffer_store_dwordx4 v[64:67], v6, s[28:31], s70 offen offset:0 sc1
s_waitcnt lgkmcnt(4)
buffer_store_dwordx4 v[68:71], v6, s[28:31], s70 offen offset:64 sc1
s_add_u32 s70, s70, 65536
s_waitcnt lgkmcnt(2)
buffer_store_dwordx4 v[72:75], v6, s[28:31], s70 offen offset:0 sc1
s_waitcnt lgkmcnt(0)
buffer_store_dwordx4 v[76:79], v6, s[28:31], s70 offen offset:64 sc1
s_add_u32 s70, s70, 65536
s_mov_b64 exec, 1
v_mov_b32 v36, 1
ds_add_u32 v230, v36 offset:16
s_mov_b64 exec, -1
s_waitcnt vmcnt(0)
s_mov_b64 exec, 1
v_mov_b32 v36, 1
ds_add_u32 v230, v36 offset:32
s_mov_b64 exec, -1
s_and_b32 s10, s9, 7
s_lshl_b32 s11, s8, 2
s_lshr_b32 s68, s9, 3
s_add_u32 s11, s11, s68
s_mov_b32 s12, s56
s_and_b32 s13, s57, 0xffff
s_mov_b32 s14, 7077888
s_mov_b32 s15, 0x20000
v_lshrrev_b32 v204, 3, v2
v_mul_u32_u24 v196, 4096, v204
v_and_b32 v205, 7, v2
v_and_b32 v204, 2, v204
v_xor_b32 v205, v205, v204
v_lshl_add_u32 v196, v205, 4, v196
v_xor_b32 v197, 64, v196
s_lshl_b32 s74, s11, 7
s_mov_b32 s75, 524288
s_mov_b32 s76, 7077888
s_mov_b32 s77, 32768
v_mov_b32 v4, v196
v_mov_b32 v5, v197
v_lshlrev_b32 v6, 4, v2
v_add_u32 v7, 0x10000, v6
s_lshl_b32 s70, s11, 7
s_mov_b32 s69, 0
Lw55:
ds_read_b32 v8, v230 offset:8
s_add_u32 s69, s69, 1
s_waitcnt lgkmcnt(0)
v_readfirstlane_b32 s68, v8
s_cmp_ge_u32 s68, 1
s_cbranch_scc1 Le56
s_sleep 2
s_cmp_lt_u32 s69, 2097152
s_cbranch_scc1 Lw55
Le56:
s_add_u32 s81, s70, 4194304
buffer_load_dwordx4 v[36:39], v4, s[12:15], s81 offen
s_add_u32 s81, s70, 4227072
buffer_load_dwordx4 v[40:43], v5, s[12:15], s81 offen
s_add_u32 s81, s70, 4259840
buffer_load_dwordx4 v[44:47], v4, s[12:15], s81 offen
s_add_u32 s81, s70, 4292608
buffer_load_dwordx4 v[48:51], v5, s[12:15], s81 offen
s_add_u32 s81, s70, 4325376
buffer_load_dwordx4 v[52:55], v4, s[12:15], s81 offen
s_add_u32 s81, s70, 4358144
buffer_load_dwordx4 v[56:59], v5, s[12:15], s81 offen
s_add_u32 s81, s70, 4390912
buffer_load_dwordx4 v[60:63], v4, s[12:15], s81 offen
s_add_u32 s81, s70, 4423680
buffer_load_dwordx4 v[64:67], v5, s[12:15], s81 offen
s_add_u32 s81, s70, 4456448
buffer_load_dwordx4 v[68:71], v4, s[12:15], s81 offen
s_add_u32 s81, s70, 4489216
buffer_load_dwordx4 v[72:75], v5, s[12:15], s81 offen
s_add_u32 s81, s70, 4521984
buffer_load_dwordx4 v[76:79], v4, s[12:15], s81 offen
s_add_u32 s81, s70, 4554752
buffer_load_dwordx4 v[80:83], v5, s[12:15], s81 offen
s_add_u32 s81, s70, 4587520
buffer_load_dwordx4 v[84:87], v4, s[12:15], s81 offen
s_add_u32 s81, s70, 4620288
buffer_load_dwordx4 v[88:91], v5, s[12:15], s81 offen
s_add_u32 s81, s70, 4653056
buffer_load_dwordx4 v[92:95], v4, s[12:15], s81 offen
s_add_u32 s81, s70, 4685824
buffer_load_dwordx4 v[96:99], v5, s[12:15], s81 offen
s_add_u32 s81, s70, 5242880
buffer_load_dwordx4 v[100:103], v4, s[12:15], s81 offen
s_add_u32 s81, s70, 5275648
buffer_load_dwordx4 v[104:107], v5, s[12:15], s81 offen
s_add_u32 s81, s70, 5308416
buffer_load_dwordx4 v[108:111], v4, s[12:15], s81 offen
s_add_u32 s81, s70, 5341184
buffer_load_dwordx4 v[112:115], v5, s[12:15], s81 offen
s_add_u32 s81, s70, 5373952
buffer_load_dwordx4 v[116:119], v4, s[12:15], s81 offen
s_add_u32 s81, s70, 5406720
buffer_load_dwordx4 v[120:123], v5, s[12:15], s81 offen
s_add_u32 s81, s70, 5439488
buffer_load_dwordx4 v[124:127], v4, s[12:15], s81 offen
s_add_u32 s81, s70, 5472256
buffer_load_dwordx4 v[128:131], v5, s[12:15], s81 offen
s_add_u32 s81, s70, 5505024
buffer_load_dwordx4 v[132:135], v4, s[12:15], s81 offen
s_add_u32 s81, s70, 5537792
buffer_load_dwordx4 v[136:139], v5, s[12:15], s81 offen
s_add_u32 s81, s70, 5570560
buffer_load_dwordx4 v[140:143], v4, s[12:15], s81 offen
s_add_u32 s81, s70, 5603328
buffer_load_dwordx4 v[144:147], v5, s[12:15], s81 offen
s_add_u32 s81, s70, 5636096
buffer_load_dwordx4 v[148:151], v4, s[12:15], s81 offen
s_add_u32 s81, s70, 5668864
buffer_load_dwordx4 v[152:155], v5, s[12:15], s81 offen
s_add_u32 s81, s70, 5701632
buffer_load_dwordx4 v[156:159], v4, s[12:15], s81 offen
s_add_u32 s81, s70, 5734400
buffer_load_dwordx4 v[160:163], v5, s[12:15], s81 offen
s_add_u32 s81, s70, 6815744
buffer_load_dwordx4 v[164:167], v4, s[12:15], s81 offen
s_add_u32 s81, s70, 6848512
buffer_load_dwordx4 v[168:171], v5, s[12:15], s81 offen
s_add_u32 s81, s70, 6881280
buffer_load_dwordx4 v[172:175], v4, s[12:15], s81 offen
s_add_u32 s81, s70, 6914048
buffer_load_dwordx4 v[176:179], v5, s[12:15], s81 offen
s_add_u32 s81, s70, 6946816
buffer_load_dwordx4 v[180:183], v4, s[12:15], s81 offen
s_add_u32 s81, s70, 6979584
buffer_load_dwordx4 v[184:187], v5, s[12:15], s81 offen
s_add_u32 s81, s70, 7012352
buffer_load_dwordx4 v[188:191], v4, s[12:15], s81 offen
s_add_u32 s81, s70, 7045120
buffer_load_dwordx4 v[192:195], v5, s[12:15], s81 offen
s_mov_b32 s69, 0
Lw57:
ds_read_b32 v8, v230 offset:20
s_add_u32 s69, s69, 1
s_waitcnt lgkmcnt(0)
v_readfirstlane_b32 s68, v8
s_cmp_ge_u32 s68, 12
s_cbranch_scc1 Le58
s_cmp_lt_u32 s69, 2097152
s_cbranch_scc1 Lw57
Le58:
s_waitcnt vmcnt(0)
ds_write_b128 v6, v[36:39] offset:0
ds_write_b128 v6, v[40:43] offset:1024
ds_write_b128 v6, v[44:47] offset:2048
ds_write_b128 v6, v[48:51] offset:3072
ds_write_b128 v6, v[52:55] offset:32768
ds_write_b128 v6, v[56:59] offset:33792
ds_write_b128 v6, v[60:63] offset:34816
ds_write_b128 v6, v[64:67] offset:35840
ds_write_b128 v7, v[68:71] offset:0
ds_write_b128 v7, v[72:75] offset:1024
ds_write_b128 v7, v[76:79] offset:2048
ds_write_b128 v7, v[80:83] offset:3072
ds_write_b128 v7, v[84:87] offset:32768
ds_write_b128 v7, v[88:91] offset:33792
ds_write_b128 v7, v[92:95] offset:34816
ds_write_b128 v7, v[96:99] offset:35840
ds_write_b128 v6, v[100:103] offset:8192
ds_write_b128 v6, v[104:107] offset:9216
ds_write_b128 v6, v[108:111] offset:10240
ds_write_b128 v6, v[112:115] offset:11264
ds_write_b128 v6, v[116:119] offset:40960
ds_write_b128 v6, v[120:123] offset:41984
ds_write_b128 v6, v[124:127] offset:43008
ds_write_b128 v6, v[128:131] offset:44032
ds_write_b128 v7, v[132:135] offset:8192
ds_write_b128 v7, v[136:139] offset:9216
ds_write_b128 v7, v[140:143] offset:10240
ds_write_b128 v7, v[144:147] offset:11264
ds_write_b128 v7, v[148:151] offset:40960
ds_write_b128 v7, v[152:155] offset:41984
ds_write_b128 v7, v[156:159] offset:43008
ds_write_b128 v7, v[160:163] offset:44032
s_mov_b64 exec, 1
v_mov_b32 v8, 1
ds_add_u32 v230, v8 offset:44
s_mov_b64 exec, -1
s_mov_b32 s69, 0
Lw59:
ds_read_b32 v8, v230 offset:20
s_add_u32 s69, s69, 1
s_waitcnt lgkmcnt(0)
v_readfirstlane_b32 s68, v8
s_cmp_ge_u32 s68, 16
s_cbranch_scc1 Le60
s_cmp_lt_u32 s69, 2097152
s_cbranch_scc1 Lw59
Le60:
ds_write_b128 v6, v[164:167] offset:20480
ds_write_b128 v6, v[168:171] offset:21504
ds_write_b128 v6, v[172:175] offset:22528
ds_write_b128 v6, v[176:179] offset:23552
ds_write_b128 v6, v[180:183] offset:53248
ds_write_b128 v6, v[184:187] offset:54272
ds_write_b128 v6, v[188:191] offset:55296
ds_write_b128 v6, v[192:195] offset:56320
s_mov_b64 exec, 1
v_mov_b32 v8, 1
ds_add_u32 v230, v8 offset:48
s_mov_b64 exec, -1
s_endpgm
L_cwave:
s_lshl_b32 s22, s8, 6
s_lshl_b32 s68, s9, 1
s_add_u32 s22, s22, s68
s_sub_u32 s68, s3, 4
s_add_u32 s22, s22, s68
s_mul_i32 s23, s68, 15504
s_add_u32 s23, s23, 131072
s_waitcnt lgkmcnt(0)
s_lshl_b32 s68, s22, 8
v_lshl_add_u32 v3, v2, 2, s68
global_load_dword v232, v3, s[38:39]
global_load_dword v233, v3, s[40:41]
global_load_dword v234, v3, s[42:43]
global_load_dword v235, v3, s[44:45]
s_add_u32 s24, s66, 12582912
s_addc_u32 s25, s67, 0
s_and_b32 s25, s25, 0xffff
s_mov_b32 s26, 262144
s_mov_b32 s27, 0x20000
s_mov_b32 s16, s66
s_and_b32 s17, s67, 0xffff
s_mov_b32 s18, 5242880
s_mov_b32 s19, 0x20000
s_barrier
s_mov_b32 s0, 0
L_chan:
s_lshr_b32 s68, s22, 1
s_lshl_b32 s68, s68, 2
s_load_dword s20, s[46:47], s68
s_load_dword s21, s[48:49], s68
s_mov_b32 s28, 0x3fb8aa3b
s_mov_b32 s29, 0x32a57060
s_mov_b32 s30, 0x3f317218
s_mov_b32 s31, 0x3e22f983
s_mov_b32 s32, 0x31dc9c88
s_mov_b32 s34, 0x46800000
s_mov_b32 s35, 0x46800000
v_and_b32 v9, 15, v2
v_lshrrev_b32 v10, 4, v2
v_lshl_add_u32 v8, v2, 6, s23
v_bfe_u32 v11, v2, 1, 2
v_xor_b32 v140, 0, v11
v_lshl_add_u32 v140, v140, 4, v8
v_xor_b32 v141, 1, v11
v_lshl_add_u32 v141, v141, 4, v8
v_xor_b32 v142, 2, v11
v_lshl_add_u32 v142, v142, 4, v8
v_xor_b32 v143, 3, v11
v_lshl_add_u32 v143, v143, 4, v8
v_lshl_add_u32 v8, v2, 5, s23
v_bfe_u32 v11, v2, 2, 1
v_xor_b32 v144, 0, v11
v_lshl_add_u32 v144, v144, 4, v8
v_xor_b32 v145, 1, v11
v_lshl_add_u32 v145, v145, 4, v8
v_bfe_u32 v8, v2, 3, 1
v_lshl_add_u32 v8, v10, 2, v8
v_bfe_u32 v11, v2, 1, 2
v_and_b32 v13, 1, v2
v_lshlrev_b32 v13, 3, v13
v_lshlrev_b32 v14, 1, v10
v_add_u32 v15, 0, v14
v_and_b32 v15, 3, v15
v_xor_b32 v15, v15, v11
v_lshl_add_u32 v15, v15, 4, v13
v_lshl_add_u32 v146, v8, 6, v15
v_add_u32 v146, s23, v146
v_add_u32 v15, 1, v14
v_and_b32 v15, 3, v15
v_xor_b32 v15, v15, v11
v_lshl_add_u32 v15, v15, 4, v13
v_lshl_add_u32 v147, v8, 6, v15
v_add_u32 v147, s23, v147
v_bfe_u32 v11, v2, 2, 1
v_and_b32 v14, 1, v10
v_xor_b32 v11, v11, v14
v_lshl_add_u32 v11, v11, 4, v13
v_lshl_add_u32 v148, v8, 5, v11
v_add_u32 v148, s23, v148
v_mov_b32 v150, 0
v_mov_b32 v24, 0
v_mov_b32 v25, 0
v_mov_b32 v26, 0
v_mov_b32 v27, 0
v_mov_b32 v28, 0
v_mov_b32 v29, 0
v_mov_b32 v30, 0
v_mov_b32 v31, 0
v_mov_b32 v32, 0
v_mov_b32 v33, 0
v_mov_b32 v34, 0
v_mov_b32 v35, 0
s_and_b32 s68, s22, 1
s_lshl_b32 s68, s68, 4
s_waitcnt lgkmcnt(0)
s_lshr_b32 s20, s20, s68
s_lshl_b32 s20, s20, 16
s_lshr_b32 s21, s21, s68
s_lshl_b32 s21, s21, 16
v_mov_b32 v12, s20
v_mul_f32 v13, s28, v12
v_fma_f32 v14, v12, s28, -v13
v_fma_f32 v14, v12, s29, v14
v_exp_f32 v13, v13
v_mul_f32 v14, s30, v14
v_fma_f32 v12, v13, v14, v13
v_cvt_pk_bf16_f32 v12, v12, v12
v_and_b32 v12, 0xffff0000, v12
s_waitcnt vmcnt(0)
v_mov_b32 v4, v232
v_mov_b32 v5, v233
v_mov_b32 v6, v234
v_mov_b32 v7, v235
s_mov_b32 s69, 0
Lw61:
ds_read_b32 v13, v230 offset:16
s_add_u32 s69, s69, 1
s_waitcnt lgkmcnt(0)
v_readfirstlane_b32 s68, v13
s_cmp_ge_u32 s68, 5
s_cbranch_scc1 Le62
s_sleep 2
s_cmp_lt_u32 s69, 2097152
s_cbranch_scc1 Lw61
Le62:
v_lshlrev_b32 v13, 16, v6
v_lshlrev_b32 v14, 16, v7
v_and_b32 v15, 0x7fff0000, v6
v_and_b32 v16, 0x7fff0000, v7
v_max3_f32 v13, |v13|, |v14|, v15
v_max_f32 v13, v13, v16
s_nop 1
v_max_f32_dpp v13, v13, v13 quad_perm:[1,0,3,2] row_mask:0xf bank_mask:0xf
s_nop 1
v_max_f32_dpp v13, v13, v13 quad_perm:[2,3,0,1] row_mask:0xf bank_mask:0xf
s_nop 1
v_max_f32_dpp v13, v13, v13 row_half_mirror row_mask:0xf bank_mask:0xf
s_nop 1
v_max_f32_dpp v13, v13, v13 row_mirror row_mask:0xf bank_mask:0xf
s_nop 0
v_readlane_b32 s82, v13, 0
v_readlane_b32 s83, v13, 16
v_readlane_b32 s84, v13, 32
v_readlane_b32 s85, v13, 48
s_max_u32 s82, s82, s83
s_max_u32 s84, s84, s85
s_max_u32 s82, s82, s84
s_lshr_b32 s82, s82, 23
s_max_u32 s82, s82, 25
s_min_u32 s82, s82, 254
s_sub_u32 s83, 265, s82
s_lshl_b32 s83, s83, 23
s_sub_u32 s84, s82, 24
s_lshl_b32 s84, s84, 23
s_mov_b32 s85, 16
L_kpass:
v_lshlrev_b32 v13, s85, v4
v_and_b32 v13, 0xffff0000, v13
v_lshlrev_b32 v14, s85, v5
v_and_b32 v14, 0xffff0000, v14
v_lshlrev_b32 v46, s85, v6
v_and_b32 v46, 0xffff0000, v46
v_lshlrev_b32 v47, s85, v7
v_and_b32 v47, 0xffff0000, v47
v_mul_f32 v15, s28, v13
v_fma_f32 v16, v13, s28, -v15
v_fma_f32 v16, v13, s29, v16
v_exp_f32 v15, v15
v_mul_f32 v16, s30, v16
v_fma_f32 v13, v15, v16, v15
v_mul_f32 v14, v14, v12
v_cvt_pk_bf16_f32 v13, v13, v13
v_and_b32 v13, 0xffff0000, v13
v_mul_f32 v15, s31, v14
v_mul_f32 v13, v13, v12
v_fma_f32 v16, v14, s31, -v15
v_mul_f32 v13, s28, v13
v_fma_f32 v16, v14, s32, v16
v_mul_f32 v46, s83, v46
v_mul_f32 v47, s83, v47
v_mul_f32 v17, 0xbf800000, v13
v_mul_f32 v18, 0x3f800000, v15
v_mul_f32 v19, 0xc1000000, v13
v_mul_f32 v20, 0x41000000, v15
v_mul_f32 v21, 0xc3000000, v13
v_mul_f32 v22, 0x43000000, v15
v_exp_f32 v17, v17
v_fract_f32 v18, v18
v_fmamk_f32 v18, v16, 0x3f800000, v18
v_exp_f32 v19, v19
v_fract_f32 v20, v20
v_fmamk_f32 v20, v16, 0x41000000, v20
v_exp_f32 v21, v21
v_fract_f32 v22, v22
v_fmamk_f32 v22, v16, 0x43000000, v22
v_cos_f32 v40, v18
v_sin_f32 v41, v18
v_cos_f32 v42, v20
v_sin_f32 v43, v20
v_cos_f32 v44, v22
v_sin_f32 v45, v22
v_mul_f32 v40, v40, v17
v_mul_f32 v41, v41, v17
v_mul_f32 v42, v42, v19
v_mul_f32 v43, v43, v19
v_mul_f32 v44, v44, v21
v_mul_f32 v45, v45, v21
.p2align 3
v_mov_b32_e64 v36, s34
v_mov_b32_e64 v37, 0
v_pk_mul_f32 v[38:39], v[42:43], s[34:35]
v_cvt_pk_f16_f32 v80, v36, v38
v_cvt_pk_f16_f32 v88, v37, v39
v_pk_mul_f32 v[36:37], v[38:39], v[42:43] op_sel:[0,0] op_sel_hi:[0,1]
v_pk_fma_f32 v[36:37], v[38:39], v[42:43], v[36:37] op_sel:[1,1,0] op_sel_hi:[1,0,1] neg_lo:[1,0,0]
v_pk_mul_f32 v[38:39], v[36:37], v[42:43] op_sel:[0,0] op_sel_hi:[0,1]
v_pk_fma_f32 v[38:39], v[36:37], v[42:43], v[38:39] op_sel:[1,1,0] op_sel_hi:[1,0,1] neg_lo:[1,0,0]
v_cvt_pk_f16_f32 v81, v36, v38
v_cvt_pk_f16_f32 v89, v37, v39
v_pk_mul_f32 v[36:37], v[38:39], v[42:43] op_sel:[0,0] op_sel_hi:[0,1]
v_pk_fma_f32 v[36:37], v[38:39], v[42:43], v[36:37] op_sel:[1,1,0] op_sel_hi:[1,0,1] neg_lo:[1,0,0]
v_pk_mul_f32 v[38:39], v[36:37], v[42:43] op_sel:[0,0] op_sel_hi:[0,1]
v_pk_fma_f32 v[38:39], v[36:37], v[42:43], v[38:39] op_sel:[1,1,0] op_sel_hi:[1,0,1] neg_lo:[1,0,0]
v_cvt_pk_f16_f32 v82, v36, v38
v_cvt_pk_f16_f32 v90, v37, v39
v_pk_mul_f32 v[36:37], v[38:39], v[42:43] op_sel:[0,0] op_sel_hi:[0,1]
v_pk_fma_f32 v[36:37], v[38:39], v[42:43], v[36:37] op_sel:[1,1,0] op_sel_hi:[1,0,1] neg_lo:[1,0,0]
v_pk_mul_f32 v[38:39], v[36:37], v[42:43] op_sel:[0,0] op_sel_hi:[0,1]
v_pk_fma_f32 v[38:39], v[36:37], v[42:43], v[38:39] op_sel:[1,1,0] op_sel_hi:[1,0,1] neg_lo:[1,0,0]
v_cvt_pk_f16_f32 v83, v36, v38
v_cvt_pk_f16_f32 v91, v37, v39
ds_write_b128 v140, v[80:83] offset:8192
ds_write_b128 v142, v[88:91] offset:8192
v_pk_mul_f32 v[36:37], v[38:39], v[42:43] op_sel:[0,0] op_sel_hi:[0,1]
v_pk_fma_f32 v[36:37], v[38:39], v[42:43], v[36:37] op_sel:[1,1,0] op_sel_hi:[1,0,1] neg_lo:[1,0,0]
v_pk_mul_f32 v[38:39], v[36:37], v[42:43] op_sel:[0,0] op_sel_hi:[0,1]
v_pk_fma_f32 v[38:39], v[36:37], v[42:43], v[38:39] op_sel:[1,1,0] op_sel_hi:[1,0,1] neg_lo:[1,0,0]
v_cvt_pk_f16_f32 v84, v36, v38
v_cvt_pk_f16_f32 v92, v37, v39
v_pk_mul_f32 v[36:37], v[38:39], v[42:43] op_sel:[0,0] op_sel_hi:[0,1]
v_pk_fma_f32 v[36:37], v[38:39], v[42:43], v[36:37] op_sel:[1,1,0] op_sel_hi:[1,0,1] neg_lo:[1,0,0]
v_pk_mul_f32 v[38:39], v[36:37], v[42:43] op_sel:[0,0] op_sel_hi:[0,1]
v_pk_fma_f32 v[38:39], v[36:37], v[42:43], v[38:39] op_sel:[1,1,0] op_sel_hi:[1,0,1] neg_lo:[1,0,0]
v_cvt_pk_f16_f32 v85, v36, v38
v_cvt_pk_f16_f32 v93, v37, v39
v_pk_mul_f32 v[36:37], v[38:39], v[42:43] op_sel:[0,0] op_sel_hi:[0,1]
v_pk_fma_f32 v[36:37], v[38:39], v[42:43], v[36:37] op_sel:[1,1,0] op_sel_hi:[1,0,1] neg_lo:[1,0,0]
v_pk_mul_f32 v[38:39], v[36:37], v[42:43] op_sel:[0,0] op_sel_hi:[0,1]
v_pk_fma_f32 v[38:39], v[36:37], v[42:43], v[38:39] op_sel:[1,1,0] op_sel_hi:[1,0,1] neg_lo:[1,0,0]
v_cvt_pk_f16_f32 v86, v36, v38
v_cvt_pk_f16_f32 v94, v37, v39
v_pk_mul_f32 v[36:37], v[38:39], v[42:43] op_sel:[0,0] op_sel_hi:[0,1]
v_pk_fma_f32 v[36:37], v[38:39], v[42:43], v[36:37] op_sel:[1,1,0] op_sel_hi:[1,0,1] neg_lo:[1,0,0]
v_pk_mul_f32 v[38:39], v[36:37], v[42:43] op_sel:[0,0] op_sel_hi:[0,1]
v_pk_fma_f32 v[38:39], v[36:37], v[42:43], v[38:39] op_sel:[1,1,0] op_sel_hi:[1,0,1] neg_lo:[1,0,0]
v_cvt_pk_f16_f32 v87, v36, v38
v_cvt_pk_f16_f32 v95, v37, v39
ds_write_b128 v141, v[84:87] offset:8192
ds_write_b128 v143, v[92:95] offset:8192
v_pk_mul_f32 v[48:49], v[46:47], v[40:41] op_sel:[0,0] op_sel_hi:[0,1]
v_pk_fma_f32 v[48:49], v[46:47], v[40:41], v[48:49] op_sel:[1,1,0] op_sel_hi:[1,0,1] neg_lo:[1,0,0]
v_cvt_pk_f16_f32 v96, v46, v48
v_cvt_pk_f16_f32 v104, -v47, -v49
v_pk_mul_f32 v[50:51], v[48:49], v[40:41] op_sel:[0,0] op_sel_hi:[0,1]
v_pk_fma_f32 v[50:51], v[48:49], v[40:41], v[50:51] op_sel:[1,1,0] op_sel_hi:[1,0,1] neg_lo:[1,0,0]
v_pk_mul_f32 v[52:53], v[50:51], v[40:41] op_sel:[0,0] op_sel_hi:[0,1]
v_pk_fma_f32 v[52:53], v[50:51], v[40:41], v[52:53] op_sel:[1,1,0] op_sel_hi:[1,0,1] neg_lo:[1,0,0]
v_cvt_pk_f16_f32 v97, v50, v52
v_cvt_pk_f16_f32 v105, -v51, -v53
v_pk_mul_f32 v[54:55], v[52:53], v[40:41] op_sel:[0,0] op_sel_hi:[0,1]
v_pk_fma_f32 v[54:55], v[52:53], v[40:41], v[54:55] op_sel:[1,1,0] op_sel_hi:[1,0,1] neg_lo:[1,0,0]
v_pk_mul_f32 v[56:57], v[54:55], v[40:41] op_sel:[0,0] op_sel_hi:[0,1]
v_pk_fma_f32 v[56:57], v[54:55], v[40:41], v[56:57] op_sel:[1,1,0] op_sel_hi:[1,0,1] neg_lo:[1,0,0]
v_cvt_pk_f16_f32 v98, v54, v56
v_cvt_pk_f16_f32 v106, -v55, -v57
v_pk_mul_f32 v[58:59], v[56:57], v[40:41] op_sel:[0,0] op_sel_hi:[0,1]
v_pk_fma_f32 v[58:59], v[56:57], v[40:41], v[58:59] op_sel:[1,1,0] op_sel_hi:[1,0,1] neg_lo:[1,0,0]
v_pk_mul_f32 v[60:61], v[58:59], v[40:41] op_sel:[0,0] op_sel_hi:[0,1]
v_pk_fma_f32 v[60:61], v[58:59], v[40:41], v[60:61] op_sel:[1,1,0] op_sel_hi:[1,0,1] neg_lo:[1,0,0]
v_cvt_pk_f16_f32 v99, v58, v60
v_cvt_pk_f16_f32 v107, -v59, -v61
ds_write_b128 v140, v[96:99] offset:0
ds_write_b128 v142, v[104:107] offset:0
v_pk_mul_f32 v[62:63], v[46:47], v[44:45] op_sel:[0,0] op_sel_hi:[0,1]
v_pk_fma_f32 v[62:63], v[46:47], v[44:45], v[62:63] op_sel:[1,1,0] op_sel_hi:[1,0,1] neg_lo:[1,0,0]
v_pk_mul_f32 v[64:65], v[48:49], v[44:45] op_sel:[0,0] op_sel_hi:[0,1]
v_pk_fma_f32 v[64:65], v[48:49], v[44:45], v[64:65] op_sel:[1,1,0] op_sel_hi:[1,0,1] neg_lo:[1,0,0]
v_cvt_pk_f16_f32 v100, v62, v64
v_cvt_pk_f16_f32 v108, -v63, -v65
v_pk_mul_f32 v[66:67], v[50:51], v[44:45] op_sel:[0,0] op_sel_hi:[0,1]
v_pk_fma_f32 v[66:67], v[50:51], v[44:45], v[66:67] op_sel:[1,1,0] op_sel_hi:[1,0,1] neg_lo:[1,0,0]
v_pk_mul_f32 v[68:69], v[52:53], v[44:45] op_sel:[0,0] op_sel_hi:[0,1]
v_pk_fma_f32 v[68:69], v[52:53], v[44:45], v[68:69] op_sel:[1,1,0] op_sel_hi:[1,0,1] neg_lo:[1,0,0]
v_cvt_pk_f16_f32 v101, v66, v68
v_cvt_pk_f16_f32 v109, -v67, -v69
v_pk_mul_f32 v[70:71], v[54:55], v[44:45] op_sel:[0,0] op_sel_hi:[0,1]
v_pk_fma_f32 v[70:71], v[54:55], v[44:45], v[70:71] op_sel:[1,1,0] op_sel_hi:[1,0,1] neg_lo:[1,0,0]
v_pk_mul_f32 v[72:73], v[56:57], v[44:45] op_sel:[0,0] op_sel_hi:[0,1]
v_pk_fma_f32 v[72:73], v[56:57], v[44:45], v[72:73] op_sel:[1,1,0] op_sel_hi:[1,0,1] neg_lo:[1,0,0]
v_cvt_pk_f16_f32 v102, v70, v72
v_cvt_pk_f16_f32 v110, -v71, -v73
v_pk_mul_f32 v[74:75], v[58:59], v[44:45] op_sel:[0,0] op_sel_hi:[0,1]
v_pk_fma_f32 v[74:75], v[58:59], v[44:45], v[74:75] op_sel:[1,1,0] op_sel_hi:[1,0,1] neg_lo:[1,0,0]
v_pk_mul_f32 v[76:77], v[60:61], v[44:45] op_sel:[0,0] op_sel_hi:[0,1]
v_pk_fma_f32 v[76:77], v[60:61], v[44:45], v[76:77] op_sel:[1,1,0] op_sel_hi:[1,0,1] neg_lo:[1,0,0]
v_cvt_pk_f16_f32 v103, v74, v76
v_cvt_pk_f16_f32 v111, -v75, -v77
ds_write_b128 v141, v[100:103] offset:0
ds_write_b128 v143, v[108:111] offset:0
v_pk_mul_f32 v[46:47], v[66:67], v[44:45] op_sel:[0,0] op_sel_hi:[0,1]
v_pk_fma_f32 v[46:47], v[66:67], v[44:45], v[46:47] op_sel:[1,1,0] op_sel_hi:[1,0,1] neg_lo:[1,0,0]
v_pk_mul_f32 v[48:49], v[74:75], v[44:45] op_sel:[0,0] op_sel_hi:[0,1]
v_pk_fma_f32 v[48:49], v[74:75], v[44:45], v[48:49] op_sel:[1,1,0] op_sel_hi:[1,0,1] neg_lo:[1,0,0]
v_cvt_pk_f16_f32 v114, v46, v48
v_cvt_pk_f16_f32 v122, -v47, -v49
v_pk_mul_f32 v[50:51], v[46:47], v[44:45] op_sel:[0,0] op_sel_hi:[0,1]
v_pk_fma_f32 v[50:51], v[46:47], v[44:45], v[50:51] op_sel:[1,1,0] op_sel_hi:[1,0,1] neg_lo:[1,0,0]
v_pk_mul_f32 v[52:53], v[48:49], v[44:45] op_sel:[0,0] op_sel_hi:[0,1]
v_pk_fma_f32 v[52:53], v[48:49], v[44:45], v[52:53] op_sel:[1,1,0] op_sel_hi:[1,0,1] neg_lo:[1,0,0]
v_cvt_pk_f16_f32 v115, v50, v52
v_cvt_pk_f16_f32 v123, -v51, -v53
v_pk_mul_f32 v[46:47], v[62:63], v[44:45] op_sel:[0,0] op_sel_hi:[0,1]
v_pk_fma_f32 v[46:47], v[62:63], v[44:45], v[46:47] op_sel:[1,1,0] op_sel_hi:[1,0,1] neg_lo:[1,0,0]
v_pk_mul_f32 v[48:49], v[70:71], v[44:45] op_sel:[0,0] op_sel_hi:[0,1]
v_pk_fma_f32 v[48:49], v[70:71], v[44:45], v[48:49] op_sel:[1,1,0] op_sel_hi:[1,0,1] neg_lo:[1,0,0]
v_cvt_pk_f16_f32 v112, v46, v48
v_cvt_pk_f16_f32 v120, -v47, -v49
v_pk_mul_f32 v[50:51], v[46:47], v[44:45] op_sel:[0,0] op_sel_hi:[0,1]
v_pk_fma_f32 v[50:51], v[46:47], v[44:45], v[50:51] op_sel:[1,1,0] op_sel_hi:[1,0,1] neg_lo:[1,0,0]
v_pk_mul_f32 v[52:53], v[48:49], v[44:45] op_sel:[0,0] op_sel_hi:[0,1]
v_pk_fma_f32 v[52:53], v[48:49], v[44:45], v[52:53] op_sel:[1,1,0] op_sel_hi:[1,0,1] neg_lo:[1,0,0]
v_cvt_pk_f16_f32 v113, v50, v52
v_cvt_pk_f16_f32 v121, -v51, -v53
ds_write_b128 v140, v[112:115] offset:4096
ds_write_b128 v142, v[120:123] offset:4096
v_pk_mul_f32 v[46:47], v[50:51], v[44:45] op_sel:[0,0] op_sel_hi:[0,1]
v_pk_fma_f32 v[46:47], v[50:51], v[44:45], v[46:47] op_sel:[1,1,0] op_sel_hi:[1,0,1] neg_lo:[1,0,0]
v_pk_mul_f32 v[48:49], v[52:53], v[44:45] op_sel:[0,0] op_sel_hi:[0,1]
v_pk_fma_f32 v[48:49], v[52:53], v[44:45], v[48:49] op_sel:[1,1,0] op_sel_hi:[1,0,1] neg_lo:[1,0,0]
v_cvt_pk_f16_f32 v116, v46, v48
v_cvt_pk_f16_f32 v124, -v47, -v49
v_pk_mul_f32 v[50:51], v[46:47], v[44:45] op_sel:[0,0] op_sel_hi:[0,1]
v_pk_fma_f32 v[50:51], v[46:47], v[44:45], v[50:51] op_sel:[1,1,0] op_sel_hi:[1,0,1] neg_lo:[1,0,0]
v_pk_mul_f32 v[52:53], v[48:49], v[44:45] op_sel:[0,0] op_sel_hi:[0,1]
v_pk_fma_f32 v[52:53], v[48:49], v[44:45], v[52:53] op_sel:[1,1,0] op_sel_hi:[1,0,1] neg_lo:[1,0,0]
v_cvt_pk_f16_f32 v117, v50, v52
v_cvt_pk_f16_f32 v125, -v51, -v53
v_pk_mul_f32 v[46:47], v[50:51], v[44:45] op_sel:[0,0] op_sel_hi:[0,1]
v_pk_fma_f32 v[46:47], v[50:51], v[44:45], v[46:47] op_sel:[1,1,0] op_sel_hi:[1,0,1] neg_lo:[1,0,0]
v_pk_mul_f32 v[48:49], v[52:53], v[44:45] op_sel:[0,0] op_sel_hi:[0,1]
v_pk_fma_f32 v[48:49], v[52:53], v[44:45], v[48:49] op_sel:[1,1,0] op_sel_hi:[1,0,1] neg_lo:[1,0,0]
v_cvt_pk_f16_f32 v118, v46, v48
v_cvt_pk_f16_f32 v126, -v47, -v49
v_pk_mul_f32 v[50:51], v[46:47], v[44:45] op_sel:[0,0] op_sel_hi:[0,1]
v_pk_fma_f32 v[50:51], v[46:47], v[44:45], v[50:51] op_sel:[1,1,0] op_sel_hi:[1,0,1] neg_lo:[1,0,0]
v_pk_mul_f32 v[52:53], v[48:49], v[44:45] op_sel:[0,0] op_sel_hi:[0,1]
v_pk_fma_f32 v[52:53], v[48:49], v[44:45], v[52:53] op_sel:[1,1,0] op_sel_hi:[1,0,1] neg_lo:[1,0,0]
v_cvt_pk_f16_f32 v119, v50, v52
v_cvt_pk_f16_f32 v127, -v51, -v53
ds_write_b128 v141, v[116:119] offset:4096
ds_write_b128 v143, v[124:127] offset:4096
v_pk_mul_f32 v[46:47], v[50:51], v[44:45] op_sel:[0,0] op_sel_hi:[0,1]
v_pk_fma_f32 v[46:47], v[50:51], v[44:45], v[46:47] op_sel:[1,1,0] op_sel_hi:[1,0,1] neg_lo:[1,0,0]
v_pk_mul_f32 v[48:49], v[46:47], v[44:45] op_sel:[0,0] op_sel_hi:[0,1]
v_pk_fma_f32 v[48:49], v[46:47], v[44:45], v[48:49] op_sel:[1,1,0] op_sel_hi:[1,0,1] neg_lo:[1,0,0]
v_cvt_pk_f16_f32 v128, v46, v48
v_cvt_pk_f16_f32 v132, -v47, -v49
v_pk_mul_f32 v[46:47], v[48:49], v[44:45] op_sel:[0,0] op_sel_hi:[0,1]
v_pk_fma_f32 v[46:47], v[48:49], v[44:45], v[46:47] op_sel:[1,1,0] op_sel_hi:[1,0,1] neg_lo:[1,0,0]
v_pk_mul_f32 v[48:49], v[46:47], v[44:45] op_sel:[0,0] op_sel_hi:[0,1]
v_pk_fma_f32 v[48:49], v[46:47], v[44:45], v[48:49] op_sel:[1,1,0] op_sel_hi:[1,0,1] neg_lo:[1,0,0]
v_cvt_pk_f16_f32 v129, v46, v48
v_cvt_pk_f16_f32 v133, -v47, -v49
v_pk_mul_f32 v[46:47], v[48:49], v[44:45] op_sel:[0,0] op_sel_hi:[0,1]
v_pk_fma_f32 v[46:47], v[48:49], v[44:45], v[46:47] op_sel:[1,1,0] op_sel_hi:[1,0,1] neg_lo:[1,0,0]
v_pk_mul_f32 v[48:49], v[46:47], v[44:45] op_sel:[0,0] op_sel_hi:[0,1]
v_pk_fma_f32 v[48:49], v[46:47], v[44:45], v[48:49] op_sel:[1,1,0] op_sel_hi:[1,0,1] neg_lo:[1,0,0]
v_cvt_pk_f16_f32 v130, v46, v48
v_cvt_pk_f16_f32 v134, -v47, -v49
v_pk_mul_f32 v[46:47], v[48:49], v[44:45] op_sel:[0,0] op_sel_hi:[0,1]
v_pk_fma_f32 v[46:47], v[48:49], v[44:45], v[46:47] op_sel:[1,1,0] op_sel_hi:[1,0,1] neg_lo:[1,0,0]
v_pk_mul_f32 v[48:49], v[46:47], v[44:45] op_sel:[0,0] op_sel_hi:[0,1]
v_pk_fma_f32 v[48:49], v[46:47], v[44:45], v[48:49] op_sel:[1,1,0] op_sel_hi:[1,0,1] neg_lo:[1,0,0]
v_cvt_pk_f16_f32 v131, v46, v48
v_cvt_pk_f16_f32 v135, -v47, -v49
ds_write_b128 v144, v[128:131] offset:12288
ds_write_b128 v145, v[132:135] offset:12288
v_fma_f32 v150, v48, v44, v150
v_fma_f32 v150, -v49, v45, v150
s_waitcnt lgkmcnt(0)
ds_read_b64_tr_b16 v[80:81], v146 offset:8192
ds_read_b64_tr_b16 v[82:83], v147 offset:8320
ds_read_b64_tr_b16 v[96:97], v146 offset:0
ds_read_b64_tr_b16 v[98:99], v147 offset:128
ds_read_b64_tr_b16 v[84:85], v146 offset:9216
ds_read_b64_tr_b16 v[86:87], v147 offset:9344
ds_read_b64_tr_b16 v[100:101], v146 offset:1024
ds_read_b64_tr_b16 v[102:103], v147 offset:1152
ds_read_b64_tr_b16 v[88:89], v146 offset:10240
ds_read_b64_tr_b16 v[90:91], v147 offset:10368
ds_read_b64_tr_b16 v[104:105], v146 offset:2048
ds_read_b64_tr_b16 v[106:107], v147 offset:2176
ds_read_b64_tr_b16 v[92:93], v146 offset:11264
ds_read_b64_tr_b16 v[94:95], v147 offset:11392
ds_read_b64_tr_b16 v[108:109], v146 offset:3072
ds_read_b64_tr_b16 v[110:111], v147 offset:3200
ds_read_b64_tr_b16 v[112:113], v146 offset:4096
ds_read_b64_tr_b16 v[114:115], v147 offset:4224
ds_read_b64_tr_b16 v[116:117], v146 offset:5120
ds_read_b64_tr_b16 v[118:119], v147 offset:5248
ds_read_b64_tr_b16 v[120:121], v146 offset:6144
ds_read_b64_tr_b16 v[122:123], v147 offset:6272
ds_read_b64_tr_b16 v[124:125], v146 offset:7168
ds_read_b64_tr_b16 v[126:127], v147 offset:7296
ds_read_b64_tr_b16 v[62:63], v148 offset:12288
ds_read_b64_tr_b16 v[64:65], v148 offset:12352
ds_read_b64_tr_b16 v[66:67], v148 offset:12800
ds_read_b64_tr_b16 v[68:69], v148 offset:12864
ds_read_b64_tr_b16 v[70:71], v148 offset:13312
ds_read_b64_tr_b16 v[72:73], v148 offset:13376
ds_read_b64_tr_b16 v[74:75], v148 offset:13824
ds_read_b64_tr_b16 v[76:77], v148 offset:13888
s_waitcnt lgkmcnt(15)
v_mfma_f32_16x16x32_f16 v[24:27], v[96:99], v[80:83], v[24:27]
v_mfma_f32_16x16x32_f16 v[24:27], v[100:103], v[84:87], v[24:27]
v_mfma_f32_16x16x32_f16 v[24:27], v[104:107], v[88:91], v[24:27]
v_mfma_f32_16x16x32_f16 v[24:27], v[108:111], v[92:95], v[24:27]
s_waitcnt lgkmcnt(8)
v_mfma_f32_16x16x32_f16 v[28:31], v[112:115], v[80:83], v[28:31]
v_mfma_f32_16x16x32_f16 v[28:31], v[116:119], v[84:87], v[28:31]
v_mfma_f32_16x16x32_f16 v[28:31], v[120:123], v[88:91], v[28:31]
v_mfma_f32_16x16x32_f16 v[28:31], v[124:127], v[92:95], v[28:31]
s_waitcnt lgkmcnt(0)
v_mfma_f32_16x16x32_f16 v[32:35], v[62:65], v[80:83], v[32:35]
v_mfma_f32_16x16x32_f16 v[32:35], v[66:69], v[84:87], v[32:35]
v_mfma_f32_16x16x32_f16 v[32:35], v[70:73], v[88:91], v[32:35]
v_mfma_f32_16x16x32_f16 v[32:35], v[74:77], v[92:95], v[32:35]
s_sub_u32 s85, s85, 16
s_cbranch_scc0 L_kpass
v_mul_f32 v12, s84, v12
v_lshlrev_b32 v13, 5, v9
v_add_u32 v13, s23, v13
v_lshrrev_b32 v14, 1, v10
v_lshlrev_b32 v14, 9, v14
v_and_b32 v15, 1, v10
v_lshl_add_u32 v14, v15, 4, v14
v_add_u32 v14, v14, v13
v_max_u32 v15, 1, v10
v_lshlrev_b32 v15, 10, v15
v_cmp_eq_u32 vcc, 1, v10
s_nop 1
v_cndmask_b32_e64 v16, 0, 8, vcc
v_add3_u32 v15, v15, v16, v13
v_lshl_add_u32 v16, v10, 11, v13
v_mul_f32 v24, v24, v12
v_mul_f32 v25, v25, v12
v_mul_f32 v26, v26, v12
v_mul_f32 v27, v27, v12
v_mul_f32 v28, v28, v12
v_mul_f32 v29, v29, v12
v_mul_f32 v30, v30, v12
v_mul_f32 v31, v31, v12
v_mul_f32 v32, v32, v12
v_mul_f32 v33, v33, v12
v_mul_f32 v34, v34, v12
v_mul_f32 v35, v35, v12
ds_write_b128 v14, v[24:27]
ds_write2_b32 v15, v28, v29 offset0:0 offset1:4
ds_write2_b32 v15, v30, v31 offset0:128 offset1:132
ds_write_b32 v16, v32 offset:4096
ds_write_b32 v16, v33 offset:4608
ds_write_b32 v16, v34 offset:5120
ds_write_b32 v16, v35 offset:5632
v_add_f32_dpp v150, v150, v150 quad_perm:[1,0,3,2] row_mask:0xf bank_mask:0xf
s_nop 1
v_add_f32_dpp v150, v150, v150 quad_perm:[2,3,0,1] row_mask:0xf bank_mask:0xf
s_nop 1
v_add_f32_dpp v150, v150, v150 row_half_mirror row_mask:0xf bank_mask:0xf
s_nop 1
v_add_f32_dpp v150, v150, v150 row_mirror row_mask:0xf bank_mask:0xf
v_mov_b32 v151, v150
s_nop 1
v_permlane16_swap_b32 v150, v151
v_add_f32 v150, v150, v151
v_mov_b32 v151, v150
s_nop 1
v_permlane32_swap_b32 v150, v151
v_add_f32 v150, v150, v151
v_mul_f32 v150, s34, v150
v_mul_f32 v150, v150, v12
v_mov_b32 v151, s23
ds_write_b32 v151, v150 offset:8192
v_lshl_add_u32 v13, v2, 5, s23
v_sub_u32 v14, 63, v2
v_lshl_add_u32 v14, v14, 4, s23
ds_read_b128 v[40:43], v13
ds_read_b128 v[44:47], v13 offset:16
ds_read_b32 v48, v13 offset:32
ds_read_b32 v49, v13 offset:2048
ds_read_b32 v50, v13 offset:2064
ds_read_b32 v51, v13 offset:2080
ds_read_b32 v52, v13 offset:4096
ds_read_b32 v53, v13 offset:4128
ds_read_b32 v54, v13 offset:6144
ds_read_b32 v55, v13 offset:6176
v_cmp_le_u32 vcc, 32, v2
v_and_b32 v15, 1, v2
v_cmp_eq_u32 s[82:83], 1, v15
v_mov_b32 v4, 0
v_mov_b32 v5, 0
v_lshl_add_u32 v6, v2, 3, s23
s_waitcnt lgkmcnt(0)
ds_write_b64 v6, v[4:5] offset:12416
s_mov_b64 exec, 0xf
ds_write_b64 v6, v[4:5]
s_mov_b64 exec, -1
v_cndmask_b32 v41, v41, v40, vcc
v_cndmask_b32 v43, v43, v44, vcc
v_cndmask_b32 v45, v45, v44, vcc
v_cndmask_b32 v47, v47, v48, vcc
v_cvt_pk_bf16_f32 v56, v47, v46
v_cvt_pk_bf16_f32 v57, v45, v44
v_cvt_pk_bf16_f32 v58, v43, v42
v_cvt_pk_bf16_f32 v59, v41, v40
ds_write_b128 v14, v[56:59] offset:11392
v_cvt_pk_bf16_f32 v60, v51, v51
v_cvt_pk_bf16_f32 v61, v50, v50
v_cvt_pk_bf16_f32 v62, v50, v49
v_cvt_pk_bf16_f32 v63, v49, v49
ds_write_b128 v14, v[60:63] offset:10368
v_cndmask_b32 v40, v52, v53, s[82:83]
v_cvt_pk_bf16_f32 v64, v53, v53
v_cvt_pk_bf16_f32 v66, v52, v52
v_cvt_pk_bf16_f32 v65, v53, v40
v_mov_b32 v67, v66
ds_write_b128 v14, v[64:67] offset:9344
v_cndmask_b32 v40, v54, v55, s[82:83]
v_cvt_pk_bf16_f32 v68, v55, v55
v_cvt_pk_bf16_f32 v70, v54, v54
v_cvt_pk_bf16_f32 v69, v55, v40
v_mov_b32 v71, v70
ds_write_b128 v14, v[68:71] offset:8320
s_add_u32 s28, s66, 2621440
s_addc_u32 s29, s67, 0
s_and_b32 s29, s29, 0xffff
s_mov_b32 s30, 2621440
s_mov_b32 s31, 0x20000
v_lshlrev_b32 v3, 4, v2
s_lshl_b32 s82, s22, 12
v_and_b32 v10, 1, v9
v_add_u32 v11, v9, v10
v_lshrrev_b32 v19, 4, v2
v_lshl_add_u32 v11, v19, 3, v11
v_lshlrev_b32 v11, 1, v11
v_xor_b32 v10, 1, v10
v_mul_u32_u24 v10, 4160, v10
v_add3_u32 v12, v11, v10, s23
v_add_u32 v13, 1024, v12
v_add_u32 v14, 2048, v12
v_add_u32 v15, 3072, v12
v_lshlrev_b32 v16, 4, v19
v_lshlrev_b32 v17, 5, v9
v_sub_u32 v16, v16, v17
s_add_u32 s83, s23, 8800
v_add_u32 v16, s83, v16
s_and_b32 s68, s3, 1
s_lshl_b32 s68, s68, 3
v_add_u32 v22, s68, v230
v_lshl_add_u32 v7, v2, 4, s23
v_lshl_add_u32 v18, v19, 3, v17
v_add_u32 v18, s23, v18
v_and_b32 v20, 1, v19
v_lshl_add_u32 v17, v20, 9, v17
v_lshrrev_b32 v20, 1, v19
v_lshl_add_u32 v17, v20, 4, v17
s_cmp_lg_u32 s3, 0
s_cbranch_scc1 Lf63
v_lshlrev_b32 v36, 7, v2
s_mov_b32 s51, 4096
s_mov_b32 s69, 0
Lp65:
buffer_load_dwordx4 v[40:43], v36, s[24:27], s51 offen sc1
s_add_u32 s69, s69, 1
s_waitcnt vmcnt(0)
v_xor_b32 v40, s6, v40
v_xor_b32 v41, s6, v41
v_xor_b32 v42, s6, v42
v_xor_b32 v43, s6, v43
v_or3_b32 v40, v40, v41, v42
v_or_b32 v40, v40, v43
v_cmp_ne_u32 vcc, 0, v40
s_and_b64 exec, exec, vcc
s_cbranch_execz Lq66
s_sleep 1
s_cmp_lt_u32 s69, 131072
s_cbranch_scc1 Lp65
Lq66:
s_mov_b64 exec, -1
v_mov_b32 v36, s6
ds_write_b32 v230, v36 offset:12
s_mov_b64 exec, 1
v_mov_b32 v36, 1
ds_add_u32 v230, v36 offset:4
s_mov_b64 exec, -1
s_cmp_lg_u32 s2, 0
s_cbranch_scc1 Lf64
s_mov_b64 exec, 1
v_mov_b32 v36, s6
v_mov_b32 v37, 0
buffer_store_dword v36, v37, s[24:27], 0 offen sc1
s_mov_b64 exec, -1
s_branch Lf64
Lf63:
s_mov_b32 s69, 0
Lw67:
ds_read_b32 v36, v230 offset:4
s_add_u32 s69, s69, 1
s_waitcnt lgkmcnt(0)
v_readfirstlane_b32 s68, v36
s_cmp_ge_u32 s68, 1
s_cbranch_scc1 Le68
s_sleep 1
s_cmp_lt_u32 s69, 2097152
s_cbranch_scc1 Lw67
Le68:
ds_read_b32 v36, v230 offset:12
s_waitcnt lgkmcnt(0)
v_readfirstlane_b32 s6, v36
Lf64:
s_add_u32 m0, s23, 32
s_nop 0
buffer_load_dwordx4 v3, s[28:31], s82 offen offset:0 sc1 lds
buffer_load_dwordx4 v3, s[28:31], s82 offen offset:1024 sc1 lds
buffer_load_dwordx4 v3, s[28:31], s82 offen offset:2048 sc1 lds
buffer_load_dwordx4 v3, s[28:31], s82 offen offset:3072 sc1 lds
v_mov_b32 v152, 0
v_mov_b32 v153, 0
v_mov_b32 v154, 0
v_mov_b32 v155, 0
v_mov_b32 v156, 0
v_mov_b32 v157, 0
v_mov_b32 v158, 0
v_mov_b32 v159, 0
v_mov_b32 v160, 0
v_mov_b32 v161, 0
v_mov_b32 v162, 0
v_mov_b32 v163, 0
v_mov_b32 v164, 0
v_mov_b32 v165, 0
v_mov_b32 v166, 0
v_mov_b32 v167, 0
v_mov_b32 v168, 0
v_mov_b32 v169, 0
v_mov_b32 v170, 0
v_mov_b32 v171, 0
v_mov_b32 v172, 0
v_mov_b32 v173, 0
v_mov_b32 v174, 0
v_mov_b32 v175, 0
v_mov_b32 v176, 0
v_mov_b32 v177, 0
v_mov_b32 v178, 0
v_mov_b32 v179, 0
v_mov_b32 v180, 0
v_mov_b32 v181, 0
v_mov_b32 v182, 0
v_mov_b32 v183, 0
s_add_u32 s28, s66, 7864320
s_addc_u32 s29, s67, 0
s_and_b32 s29, s29, 0xffff
s_mov_b32 s30, 2621440
s_mov_b32 s31, 0x20000
s_mov_b32 s20, s21
s_lshl_b32 s82, s22, 12
s_mov_b32 s85, 0
s_waitcnt vmcnt(0)
ds_read_b128 v[24:27], v7 offset:0
ds_read_b32 v28, v7 offset:16
ds_read_b128 v[32:35], v7 offset:1024
ds_read_b32 v36, v7 offset:1040
ds_read_b128 v[40:43], v7 offset:2048
ds_read_b32 v44, v7 offset:2064
ds_read_b128 v[48:51], v7 offset:3072
ds_read_b32 v52, v7 offset:3088
ds_read_b128 v[56:59], v7 offset:4096
ds_read_b32 v60, v7 offset:4112
s_waitcnt lgkmcnt(8)
v_alignbit_b32 v64, v25, v24, 16
v_alignbit_b32 v65, v26, v25, 16
v_alignbit_b32 v66, v27, v26, 16
v_alignbit_b32 v67, v28, v27, 16
ds_write_b128 v7, v[64:67] offset:4160
s_waitcnt lgkmcnt(6)
v_alignbit_b32 v68, v33, v32, 16
v_alignbit_b32 v69, v34, v33, 16
v_alignbit_b32 v70, v35, v34, 16
v_alignbit_b32 v71, v36, v35, 16
ds_write_b128 v7, v[68:71] offset:5184
s_waitcnt lgkmcnt(4)
v_alignbit_b32 v72, v41, v40, 16
v_alignbit_b32 v73, v42, v41, 16
v_alignbit_b32 v74, v43, v42, 16
v_alignbit_b32 v75, v44, v43, 16
ds_write_b128 v7, v[72:75] offset:6208
s_waitcnt lgkmcnt(2)
v_alignbit_b32 v76, v49, v48, 16
v_alignbit_b32 v77, v50, v49, 16
v_alignbit_b32 v78, v51, v50, 16
v_alignbit_b32 v79, v52, v51, 16
ds_write_b128 v7, v[76:79] offset:7232
s_waitcnt lgkmcnt(0)
v_alignbit_b32 v80, v57, v56, 16
v_alignbit_b32 v81, v58, v57, 16
v_alignbit_b32 v82, v59, v58, 16
v_alignbit_b32 v83, v60, v59, 16
s_mov_b64 exec, 3
ds_write_b128 v7, v[80:83] offset:8256
s_mov_b64 exec, -1
L_convstart:
v_mov_b32 v21, 0
ds_read_b128 v[56:59], v16 offset:3584
ds_read2_b32 v[24:25], v12 offset0:0 offset1:1
ds_read2_b32 v[26:27], v12 offset0:2 offset1:3
ds_read_b128 v[60:63], v16 offset:3072
ds_read2_b32 v[28:29], v12 offset0:128 offset1:129
ds_read2_b32 v[30:31], v12 offset0:130 offset1:131
ds_read_b128 v[64:67], v16 offset:2560
ds_read2_b32 v[32:33], v13 offset0:0 offset1:1
ds_read2_b32 v[34:35], v13 offset0:2 offset1:3
ds_read_b128 v[68:71], v16 offset:2048
ds_read2_b32 v[36:37], v13 offset0:128 offset1:129
ds_read2_b32 v[38:39], v13 offset0:130 offset1:131
ds_read_b128 v[72:75], v16 offset:1536
ds_read2_b32 v[40:41], v14 offset0:0 offset1:1
ds_read2_b32 v[42:43], v14 offset0:2 offset1:3
ds_read_b128 v[76:79], v16 offset:1024
ds_read2_b32 v[44:45], v14 offset0:128 offset1:129
ds_read2_b32 v[46:47], v14 offset0:130 offset1:131
ds_read_b128 v[80:83], v16 offset:512
ds_read2_b32 v[48:49], v15 offset0:0 offset1:1
ds_read2_b32 v[50:51], v15 offset0:2 offset1:3
ds_read_b128 v[84:87], v16 offset:0
ds_read2_b32 v[52:53], v15 offset0:128 offset1:129
ds_read2_b32 v[54:55], v15 offset0:130 offset1:131
.p2align 3
L_conv:
s_waitcnt lgkmcnt(0)
s_nop 0
v_readfirstlane_b32 s68, v21
s_cmp_eq_u32 s68, 0
s_cbranch_scc1 Ly69
s_mov_b32 s69, 0
Lw70:
ds_read_b32 v21, v230 offset:60
s_add_u32 s69, s69, 1
s_waitcnt lgkmcnt(0)
v_readfirstlane_b32 s68, v21
s_cmp_ge_u32 s68, 4
s_cbranch_scc1 Le71
s_sleep 2
s_cmp_lt_u32 s69, 2097152
s_cbranch_scc1 Lw70
Le71:
Ly69:
ds_read_b32 v21, v230 offset:56
v_mfma_f32_16x16x32_bf16 v[152:155], v[24:27], v[56:59], v[152:155]
ds_read_b128 v[120:123], v16 offset:3648
v_mfma_f32_16x16x32_bf16 v[156:159], v[24:27], v[60:63], v[156:159]
ds_read2_b32 v[88:89], v12 offset0:16 offset1:17
v_mfma_f32_16x16x32_bf16 v[160:163], v[24:27], v[64:67], v[160:163]
ds_read2_b32 v[90:91], v12 offset0:18 offset1:19
v_mfma_f32_16x16x32_bf16 v[164:167], v[24:27], v[68:71], v[164:167]
ds_read_b128 v[124:127], v16 offset:3136
v_mfma_f32_16x16x32_bf16 v[168:171], v[24:27], v[72:75], v[168:171]
ds_read2_b32 v[92:93], v12 offset0:144 offset1:145
v_mfma_f32_16x16x32_bf16 v[172:175], v[24:27], v[76:79], v[172:175]
ds_read2_b32 v[94:95], v12 offset0:146 offset1:147
v_mfma_f32_16x16x32_bf16 v[176:179], v[24:27], v[80:83], v[176:179]
ds_read_b128 v[128:131], v16 offset:2624
v_mfma_f32_16x16x32_bf16 v[180:183], v[24:27], v[84:87], v[180:183]
ds_read2_b32 v[96:97], v13 offset0:16 offset1:17
v_mfma_f32_16x16x32_bf16 v[156:159], v[28:31], v[56:59], v[156:159]
ds_read2_b32 v[98:99], v13 offset0:18 offset1:19
v_mfma_f32_16x16x32_bf16 v[160:163], v[28:31], v[60:63], v[160:163]
ds_read_b128 v[132:135], v16 offset:2112
v_mfma_f32_16x16x32_bf16 v[164:167], v[28:31], v[64:67], v[164:167]
ds_read2_b32 v[100:101], v13 offset0:144 offset1:145
v_mfma_f32_16x16x32_bf16 v[168:171], v[28:31], v[68:71], v[168:171]
ds_read2_b32 v[102:103], v13 offset0:146 offset1:147
v_mfma_f32_16x16x32_bf16 v[172:175], v[28:31], v[72:75], v[172:175]
ds_read_b128 v[136:139], v16 offset:1600
v_mfma_f32_16x16x32_bf16 v[176:179], v[28:31], v[76:79], v[176:179]
ds_read2_b32 v[104:105], v14 offset0:16 offset1:17
v_mfma_f32_16x16x32_bf16 v[180:183], v[28:31], v[80:83], v[180:183]
ds_read2_b32 v[106:107], v14 offset0:18 offset1:19
v_mfma_f32_16x16x32_bf16 v[160:163], v[32:35], v[56:59], v[160:163]
ds_read_b128 v[140:143], v16 offset:1088
v_mfma_f32_16x16x32_bf16 v[164:167], v[32:35], v[60:63], v[164:167]
ds_read2_b32 v[108:109], v14 offset0:144 offset1:145
v_mfma_f32_16x16x32_bf16 v[168:171], v[32:35], v[64:67], v[168:171]
ds_read2_b32 v[110:111], v14 offset0:146 offset1:147
v_mfma_f32_16x16x32_bf16 v[172:175], v[32:35], v[68:71], v[172:175]
ds_read_b128 v[144:147], v16 offset:576
v_mfma_f32_16x16x32_bf16 v[176:179], v[32:35], v[72:75], v[176:179]
ds_read2_b32 v[112:113], v15 offset0:16 offset1:17
v_mfma_f32_16x16x32_bf16 v[180:183], v[32:35], v[76:79], v[180:183]
ds_read2_b32 v[114:115], v15 offset0:18 offset1:19
v_mfma_f32_16x16x32_bf16 v[164:167], v[36:39], v[56:59], v[164:167]
ds_read_b128 v[148:151], v16 offset:64
v_mfma_f32_16x16x32_bf16 v[168:171], v[36:39], v[60:63], v[168:171]
ds_read2_b32 v[116:117], v15 offset0:144 offset1:145
v_mfma_f32_16x16x32_bf16 v[172:175], v[36:39], v[64:67], v[172:175]
ds_read2_b32 v[118:119], v15 offset0:146 offset1:147
v_mfma_f32_16x16x32_bf16 v[176:179], v[36:39], v[68:71], v[176:179]
v_mfma_f32_16x16x32_bf16 v[180:183], v[36:39], v[72:75], v[180:183]
v_mfma_f32_16x16x32_bf16 v[168:171], v[40:43], v[56:59], v[168:171]
v_mfma_f32_16x16x32_bf16 v[172:175], v[40:43], v[60:63], v[172:175]
v_mfma_f32_16x16x32_bf16 v[176:179], v[40:43], v[64:67], v[176:179]
v_mfma_f32_16x16x32_bf16 v[180:183], v[40:43], v[68:71], v[180:183]
v_mfma_f32_16x16x32_bf16 v[172:175], v[44:47], v[56:59], v[172:175]
v_mfma_f32_16x16x32_bf16 v[176:179], v[44:47], v[60:63], v[176:179]
v_mfma_f32_16x16x32_bf16 v[180:183], v[44:47], v[64:67], v[180:183]
v_mfma_f32_16x16x32_bf16 v[176:179], v[48:51], v[56:59], v[176:179]
v_mfma_f32_16x16x32_bf16 v[180:183], v[48:51], v[60:63], v[180:183]
v_mfma_f32_16x16x32_bf16 v[180:183], v[52:55], v[56:59], v[180:183]
s_waitcnt lgkmcnt(0)
s_nop 0
v_readfirstlane_b32 s68, v21
s_cmp_eq_u32 s68, 0
s_cbranch_scc1 Ly72
s_mov_b32 s69, 0
Lw73:
ds_read_b32 v21, v230 offset:60
s_add_u32 s69, s69, 1
s_waitcnt lgkmcnt(0)
v_readfirstlane_b32 s68, v21
s_cmp_ge_u32 s68, 4
s_cbranch_scc1 Le74
s_sleep 2
s_cmp_lt_u32 s69, 2097152
s_cbranch_scc1 Lw73
Le74:
Ly72:
ds_read_b32 v21, v230 offset:56
v_mfma_f32_16x16x32_bf16 v[152:155], v[88:91], v[120:123], v[152:155]
ds_read_b128 v[56:59], v16 offset:3712
v_mfma_f32_16x16x32_bf16 v[156:159], v[88:91], v[124:127], v[156:159]
ds_read2_b32 v[24:25], v12 offset0:32 offset1:33
v_mfma_f32_16x16x32_bf16 v[160:163], v[88:91], v[128:131], v[160:163]
ds_read2_b32 v[26:27], v12 offset0:34 offset1:35
v_mfma_f32_16x16x32_bf16 v[164:167], v[88:91], v[132:135], v[164:167]
ds_read_b128 v[60:63], v16 offset:3200
v_mfma_f32_16x16x32_bf16 v[168:171], v[88:91], v[136:139], v[168:171]
ds_read2_b32 v[28:29], v12 offset0:160 offset1:161
v_mfma_f32_16x16x32_bf16 v[172:175], v[88:91], v[140:143], v[172:175]
ds_read2_b32 v[30:31], v12 offset0:162 offset1:163
v_mfma_f32_16x16x32_bf16 v[176:179], v[88:91], v[144:147], v[176:179]
ds_read_b128 v[64:67], v16 offset:2688
v_mfma_f32_16x16x32_bf16 v[180:183], v[88:91], v[148:151], v[180:183]
ds_read2_b32 v[32:33], v13 offset0:32 offset1:33
v_mfma_f32_16x16x32_bf16 v[156:159], v[92:95], v[120:123], v[156:159]
ds_read2_b32 v[34:35], v13 offset0:34 offset1:35
v_mfma_f32_16x16x32_bf16 v[160:163], v[92:95], v[124:127], v[160:163]
ds_read_b128 v[68:71], v16 offset:2176
v_mfma_f32_16x16x32_bf16 v[164:167], v[92:95], v[128:131], v[164:167]
ds_read2_b32 v[36:37], v13 offset0:160 offset1:161
v_mfma_f32_16x16x32_bf16 v[168:171], v[92:95], v[132:135], v[168:171]
ds_read2_b32 v[38:39], v13 offset0:162 offset1:163
v_mfma_f32_16x16x32_bf16 v[172:175], v[92:95], v[136:139], v[172:175]
ds_read_b128 v[72:75], v16 offset:1664
v_mfma_f32_16x16x32_bf16 v[176:179], v[92:95], v[140:143], v[176:179]
ds_read2_b32 v[40:41], v14 offset0:32 offset1:33
v_mfma_f32_16x16x32_bf16 v[180:183], v[92:95], v[144:147], v[180:183]
ds_read2_b32 v[42:43], v14 offset0:34 offset1:35
v_mfma_f32_16x16x32_bf16 v[160:163], v[96:99], v[120:123], v[160:163]
ds_read_b128 v[76:79], v16 offset:1152
v_mfma_f32_16x16x32_bf16 v[164:167], v[96:99], v[124:127], v[164:167]
ds_read2_b32 v[44:45], v14 offset0:160 offset1:161
v_mfma_f32_16x16x32_bf16 v[168:171], v[96:99], v[128:131], v[168:171]
ds_read2_b32 v[46:47], v14 offset0:162 offset1:163
v_mfma_f32_16x16x32_bf16 v[172:175], v[96:99], v[132:135], v[172:175]
ds_read_b128 v[80:83], v16 offset:640
v_mfma_f32_16x16x32_bf16 v[176:179], v[96:99], v[136:139], v[176:179]
ds_read2_b32 v[48:49], v15 offset0:32 offset1:33
v_mfma_f32_16x16x32_bf16 v[180:183], v[96:99], v[140:143], v[180:183]
ds_read2_b32 v[50:51], v15 offset0:34 offset1:35
v_mfma_f32_16x16x32_bf16 v[164:167], v[100:103], v[120:123], v[164:167]
ds_read_b128 v[84:87], v16 offset:128
v_mfma_f32_16x16x32_bf16 v[168:171], v[100:103], v[124:127], v[168:171]
ds_read2_b32 v[52:53], v15 offset0:160 offset1:161
v_mfma_f32_16x16x32_bf16 v[172:175], v[100:103], v[128:131], v[172:175]
ds_read2_b32 v[54:55], v15 offset0:162 offset1:163
v_mfma_f32_16x16x32_bf16 v[176:179], v[100:103], v[132:135], v[176:179]
v_mfma_f32_16x16x32_bf16 v[180:183], v[100:103], v[136:139], v[180:183]
v_mfma_f32_16x16x32_bf16 v[168:171], v[104:107], v[120:123], v[168:171]
v_mfma_f32_16x16x32_bf16 v[172:175], v[104:107], v[124:127], v[172:175]
v_mfma_f32_16x16x32_bf16 v[176:179], v[104:107], v[128:131], v[176:179]
v_mfma_f32_16x16x32_bf16 v[180:183], v[104:107], v[132:135], v[180:183]
v_mfma_f32_16x16x32_bf16 v[172:175], v[108:111], v[120:123], v[172:175]
v_mfma_f32_16x16x32_bf16 v[176:179], v[108:111], v[124:127], v[176:179]
v_mfma_f32_16x16x32_bf16 v[180:183], v[108:111], v[128:131], v[180:183]
v_mfma_f32_16x16x32_bf16 v[176:179], v[112:115], v[120:123], v[176:179]
v_mfma_f32_16x16x32_bf16 v[180:183], v[112:115], v[124:127], v[180:183]
v_mfma_f32_16x16x32_bf16 v[180:183], v[116:119], v[120:123], v[180:183]
v_add_u32 v12, 128, v12
v_add_u32 v13, 128, v13
v_add_u32 v14, 128, v14
v_add_u32 v15, 128, v15
v_add_u32 v16, 128, v16
s_add_u32 s85, s85, 1
s_cmp_lt_u32 s85, 4
s_cbranch_scc1 L_conv
s_waitcnt lgkmcnt(0)
ds_read_b64 v[24:25], v18 offset:32
ds_read_b64 v[28:29], v18 offset:544
ds_read_b64 v[32:33], v18 offset:1056
ds_read_b64 v[36:37], v18 offset:1568
ds_read_b64 v[40:41], v18 offset:2080
ds_read_b64 v[44:45], v18 offset:2592
ds_read_b64 v[48:49], v18 offset:3104
ds_read_b64 v[52:53], v18 offset:3616
s_waitcnt lgkmcnt(0)
v_lshlrev_b32 v26, 16, v25
v_and_b32 v27, 0xffff0000, v25
v_and_b32 v25, 0xffff0000, v24
v_lshlrev_b32 v24, 16, v24
v_lshlrev_b32 v30, 16, v29
v_and_b32 v31, 0xffff0000, v29
v_and_b32 v29, 0xffff0000, v28
v_lshlrev_b32 v28, 16, v28
v_lshlrev_b32 v34, 16, v33
v_and_b32 v35, 0xffff0000, v33
v_and_b32 v33, 0xffff0000, v32
v_lshlrev_b32 v32, 16, v32
v_lshlrev_b32 v38, 16, v37
v_and_b32 v39, 0xffff0000, v37
v_and_b32 v37, 0xffff0000, v36
v_lshlrev_b32 v36, 16, v36
v_lshlrev_b32 v42, 16, v41
v_and_b32 v43, 0xffff0000, v41
v_and_b32 v41, 0xffff0000, v40
v_lshlrev_b32 v40, 16, v40
v_lshlrev_b32 v46, 16, v45
v_and_b32 v47, 0xffff0000, v45
v_and_b32 v45, 0xffff0000, v44
v_lshlrev_b32 v44, 16, v44
v_lshlrev_b32 v50, 16, v49
v_and_b32 v51, 0xffff0000, v49
v_and_b32 v49, 0xffff0000, v48
v_lshlrev_b32 v48, 16, v48
v_lshlrev_b32 v54, 16, v53
v_and_b32 v55, 0xffff0000, v53
v_and_b32 v53, 0xffff0000, v52
v_lshlrev_b32 v52, 16, v52
v_pk_mul_f32 v[24:25], v[24:25], s[20:21]
v_pk_mul_f32 v[26:27], v[26:27], s[20:21]
v_pk_mul_f32 v[28:29], v[28:29], s[20:21]
v_pk_mul_f32 v[30:31], v[30:31], s[20:21]
v_pk_mul_f32 v[32:33], v[32:33], s[20:21]
v_pk_mul_f32 v[34:35], v[34:35], s[20:21]
v_pk_mul_f32 v[36:37], v[36:37], s[20:21]
v_pk_mul_f32 v[38:39], v[38:39], s[20:21]
v_pk_mul_f32 v[40:41], v[40:41], s[20:21]
v_pk_mul_f32 v[42:43], v[42:43], s[20:21]
v_pk_mul_f32 v[44:45], v[44:45], s[20:21]
v_pk_mul_f32 v[46:47], v[46:47], s[20:21]
v_pk_mul_f32 v[48:49], v[48:49], s[20:21]
v_pk_mul_f32 v[50:51], v[50:51], s[20:21]
v_pk_mul_f32 v[52:53], v[52:53], s[20:21]
v_pk_mul_f32 v[54:55], v[54:55], s[20:21]
v_cvt_pk_bf16_f32 v24, v24, v25
v_cvt_pk_bf16_f32 v26, v26, v27
v_cvt_pk_bf16_f32 v28, v28, v29
v_cvt_pk_bf16_f32 v30, v30, v31
v_cvt_pk_bf16_f32 v32, v32, v33
v_cvt_pk_bf16_f32 v34, v34, v35
v_cvt_pk_bf16_f32 v36, v36, v37
v_cvt_pk_bf16_f32 v38, v38, v39
v_cvt_pk_bf16_f32 v40, v40, v41
v_cvt_pk_bf16_f32 v42, v42, v43
v_cvt_pk_bf16_f32 v44, v44, v45
v_cvt_pk_bf16_f32 v46, v46, v47
v_cvt_pk_bf16_f32 v48, v48, v49
v_cvt_pk_bf16_f32 v50, v50, v51
v_cvt_pk_bf16_f32 v52, v52, v53
v_cvt_pk_bf16_f32 v54, v54, v55
v_and_b32 v25, 0xffff0000, v24
v_lshlrev_b32 v24, 16, v24
v_and_b32 v27, 0xffff0000, v26
v_lshlrev_b32 v26, 16, v26
v_and_b32 v29, 0xffff0000, v28
v_lshlrev_b32 v28, 16, v28
v_and_b32 v31, 0xffff0000, v30
v_lshlrev_b32 v30, 16, v30
v_and_b32 v33, 0xffff0000, v32
v_lshlrev_b32 v32, 16, v32
v_and_b32 v35, 0xffff0000, v34
v_lshlrev_b32 v34, 16, v34
v_and_b32 v37, 0xffff0000, v36
v_lshlrev_b32 v36, 16, v36
v_and_b32 v39, 0xffff0000, v38
v_lshlrev_b32 v38, 16, v38
v_and_b32 v41, 0xffff0000, v40
v_lshlrev_b32 v40, 16, v40
v_and_b32 v43, 0xffff0000, v42
v_lshlrev_b32 v42, 16, v42
v_and_b32 v45, 0xffff0000, v44
v_lshlrev_b32 v44, 16, v44
v_and_b32 v47, 0xffff0000, v46
v_lshlrev_b32 v46, 16, v46
v_and_b32 v49, 0xffff0000, v48
v_lshlrev_b32 v48, 16, v48
v_and_b32 v51, 0xffff0000, v50
v_lshlrev_b32 v50, 16, v50
v_and_b32 v53, 0xffff0000, v52
v_lshlrev_b32 v52, 16, v52
v_and_b32 v55, 0xffff0000, v54
v_lshlrev_b32 v54, 16, v54
v_cvt_pk_bf16_f32 v56, v152, v153
v_cvt_pk_bf16_f32 v58, v154, v155
v_cvt_pk_bf16_f32 v60, v156, v157
v_cvt_pk_bf16_f32 v62, v158, v159
v_cvt_pk_bf16_f32 v64, v160, v161
v_cvt_pk_bf16_f32 v66, v162, v163
v_cvt_pk_bf16_f32 v68, v164, v165
v_cvt_pk_bf16_f32 v70, v166, v167
v_cvt_pk_bf16_f32 v72, v168, v169
v_cvt_pk_bf16_f32 v74, v170, v171
v_cvt_pk_bf16_f32 v76, v172, v173
v_cvt_pk_bf16_f32 v78, v174, v175
v_cvt_pk_bf16_f32 v80, v176, v177
v_cvt_pk_bf16_f32 v82, v178, v179
v_cvt_pk_bf16_f32 v84, v180, v181
v_cvt_pk_bf16_f32 v86, v182, v183
v_and_b32 v57, 0xffff0000, v56
v_lshlrev_b32 v56, 16, v56
v_and_b32 v59, 0xffff0000, v58
v_lshlrev_b32 v58, 16, v58
v_and_b32 v61, 0xffff0000, v60
v_lshlrev_b32 v60, 16, v60
v_and_b32 v63, 0xffff0000, v62
v_lshlrev_b32 v62, 16, v62
v_and_b32 v65, 0xffff0000, v64
v_lshlrev_b32 v64, 16, v64
v_and_b32 v67, 0xffff0000, v66
v_lshlrev_b32 v66, 16, v66
v_and_b32 v69, 0xffff0000, v68
v_lshlrev_b32 v68, 16, v68
v_and_b32 v71, 0xffff0000, v70
v_lshlrev_b32 v70, 16, v70
v_and_b32 v73, 0xffff0000, v72
v_lshlrev_b32 v72, 16, v72
v_and_b32 v75, 0xffff0000, v74
v_lshlrev_b32 v74, 16, v74
v_and_b32 v77, 0xffff0000, v76
v_lshlrev_b32 v76, 16, v76
v_and_b32 v79, 0xffff0000, v78
v_lshlrev_b32 v78, 16, v78
v_and_b32 v81, 0xffff0000, v80
v_lshlrev_b32 v80, 16, v80
v_and_b32 v83, 0xffff0000, v82
v_lshlrev_b32 v82, 16, v82
v_and_b32 v85, 0xffff0000, v84
v_lshlrev_b32 v84, 16, v84
v_and_b32 v87, 0xffff0000, v86
v_lshlrev_b32 v86, 16, v86
v_pk_add_f32 v[24:25], v[24:25], v[56:57]
v_pk_add_f32 v[26:27], v[26:27], v[58:59]
v_pk_add_f32 v[28:29], v[28:29], v[60:61]
v_pk_add_f32 v[30:31], v[30:31], v[62:63]
v_pk_add_f32 v[32:33], v[32:33], v[64:65]
v_pk_add_f32 v[34:35], v[34:35], v[66:67]
v_pk_add_f32 v[36:37], v[36:37], v[68:69]
v_pk_add_f32 v[38:39], v[38:39], v[70:71]
v_pk_add_f32 v[40:41], v[40:41], v[72:73]
v_pk_add_f32 v[42:43], v[42:43], v[74:75]
v_pk_add_f32 v[44:45], v[44:45], v[76:77]
v_pk_add_f32 v[46:47], v[46:47], v[78:79]
v_pk_add_f32 v[48:49], v[48:49], v[80:81]
v_pk_add_f32 v[50:51], v[50:51], v[82:83]
v_pk_add_f32 v[52:53], v[52:53], v[84:85]
v_pk_add_f32 v[54:55], v[54:55], v[86:87]
v_cvt_pk_bf16_f32 v88, v24, v25
v_cvt_pk_bf16_f32 v89, v26, v27
v_cvt_pk_bf16_f32 v90, v28, v29
v_cvt_pk_bf16_f32 v91, v30, v31
v_cvt_pk_bf16_f32 v92, v32, v33
v_cvt_pk_bf16_f32 v93, v34, v35
v_cvt_pk_bf16_f32 v94, v36, v37
v_cvt_pk_bf16_f32 v95, v38, v39
v_cvt_pk_bf16_f32 v96, v40, v41
v_cvt_pk_bf16_f32 v97, v42, v43
v_cvt_pk_bf16_f32 v98, v44, v45
v_cvt_pk_bf16_f32 v99, v46, v47
v_cvt_pk_bf16_f32 v100, v48, v49
v_cvt_pk_bf16_f32 v101, v50, v51
v_cvt_pk_bf16_f32 v102, v52, v53
v_cvt_pk_bf16_f32 v103, v54, v55
v_permlane16_swap_b32 v88, v90
v_permlane16_swap_b32 v89, v91
v_permlane16_swap_b32 v92, v94
v_permlane16_swap_b32 v93, v95
v_permlane16_swap_b32 v96, v98
v_permlane16_swap_b32 v97, v99
v_permlane16_swap_b32 v100, v102
v_permlane16_swap_b32 v101, v103
buffer_store_dwordx4 v[88:91], v17, s[28:31], s82 offen offset:0 sc1
buffer_store_dwordx4 v[92:95], v17, s[28:31], s82 offen offset:1024 sc1
buffer_store_dwordx4 v[96:99], v17, s[28:31], s82 offen offset:2048 sc1
buffer_store_dwordx4 v[100:103], v17, s[28:31], s82 offen offset:3072 sc1
s_lshr_b32 s82, s22, 2
s_lshl_b32 s82, s82, 7
s_and_b32 s83, s22, 3
s_lshl_b32 s83, s83, 2
s_add_u32 s82, s82, s83
s_add_u32 s82, s82, 131072
s_waitcnt vmcnt(0)
s_mov_b64 exec, 1
v_mov_b32 v4, s6
v_mov_b32 v5, 0
buffer_store_dword v4, v5, s[24:27], s82 offen sc1
s_mov_b64 exec, -1
s_cmp_eq_u32 s0, 1
s_cbranch_scc1 L_chan_ret
L_end:
s_endpgm
L_codeend:
.section .rodata,"a"
.p2align 6
.amdhsa_kernel gated_mix__ssm_conv_s4d__mixer_token_mlp__prompt_kernel
  .amdhsa_next_free_vgpr 240
  .amdhsa_next_free_sgpr 102
  .amdhsa_accum_offset 240
  .amdhsa_group_segment_fixed_size 0
  .amdhsa_kernarg_size 128
  .amdhsa_user_sgpr_count 2
  .amdhsa_user_sgpr_kernarg_segment_ptr 1
  .amdhsa_system_sgpr_workgroup_id_x 1
.end_amdhsa_kernel
```
